```python
import torch

def _softmax(x, axis=-1):
    return torch.softmax(x, dim=axis)
def _gelu(x):
    return torch.nn.functional.gelu(x, approximate="tanh")
def _silu(x):
    return torch.nn.functional.silu(x)
def _sigmoid(x):
    return torch.sigmoid(x)
def _layernorm(x, axis=-1, eps=1e-5):
    m = x.mean(dim=axis, keepdim=True)
    v = x.var(dim=axis, keepdim=True, unbiased=False)
    return (x - m) / torch.sqrt(v + eps)
def _scatter_add(tgt, idx, src, axis=0):
    return tgt.clone().index_add_(axis, idx, src)
def _segment_sum(src, seg, n):
    out = torch.zeros((n,) + src.shape[1:], dtype=src.dtype)
    return out.index_add_(0, seg, src)
def _pad(x, pw):
    flat = tuple(v for pair in reversed(pw) for v in pair)
    return torch.nn.functional.pad(x, flat)

kernel_name = 'parallel_sum__sliding_block__dense_activation_relu__prompt'

def setup_inputs():

    _w = (lambda a: (lambda t: t.to(torch.bfloat16) if t.is_floating_point() else t)(torch.as_tensor(a)))
    def _A_setup():
        B, S, D = 1, 2048, 512
        return {
            "x": _w((lambda *s: torch.randn(*s, dtype=torch.bfloat16) * 0.05)(B, S, D)),
            "wqkv": _w((lambda *s: torch.randn(*s, dtype=torch.bfloat16) * 0.05)(D, 3 * D)),
            "wo": _w((lambda *s: torch.randn(*s, dtype=torch.bfloat16) * 0.1)(D, D)),
        }
    _A_in = _A_setup()

    def _B_setup():
        B, S, D, Dff = 1, 2048, 512, 1792
        return {
            "x": _w((lambda *s: torch.randn(*s, dtype=torch.bfloat16) * 0.05)(B, S, D)),
            "w1": _w((lambda *s: torch.randn(*s, dtype=torch.bfloat16) * 0.05)(D, Dff)),
            "w2": _w((lambda *s: torch.randn(*s, dtype=torch.bfloat16) * 0.05)(Dff, D)),
        }
    _B_in = _B_setup()

    return {
        "A_x": _A_in["x"],
        "A_wqkv": _A_in["wqkv"],
        "A_wo": _A_in["wo"],
        "B_x": _B_in["x"],
        "B_w1": _B_in["w1"],
        "B_w2": _B_in["w2"],
    }

def reference(A_x, A_wqkv, A_wo, B_x, B_w1, B_w2):
    def _A_ref(x, wqkv, wo):
        B, S, D = x.shape
        H = 32; Dh = D // H; W = 256
        qkv = (lambda x, *d: x.permute(*d))((x @ wqkv).reshape(B, S, 3, H, Dh), 2, 0, 3, 1, 4)
        q, k, v = qkv[0], qkv[1], qkv[2]
        scores = torch.einsum("bhqd,bhkd->bhqk", q, k) * (Dh ** -0.5)
        idx = torch.arange(S)
        mask = (idx[:, None] - idx[None, :] >= 0) & (idx[:, None] - idx[None, :] < W)
        scores = torch.where(mask[None, None], scores, -1e9)
        p = _softmax(scores, axis=-1)
        o = torch.einsum("bhqk,bhkd->bhqd", p, v)
        return (lambda x, *d: x.permute(*d))(o, 0, 2, 1, 3).reshape(B, S, D) @ wo

    def _B_ref(x, w1, w2):
        h = torch.einsum("bsd,df->bsf", x, w1)
        zero = torch.zeros_like(h)
        h = torch.maximum(h, zero)
        return torch.einsum("bsf,fd->bsd", h, w2)

    x = A_x
    xn = _layernorm(x, axis=-1)
    return x + _A_ref(xn, A_wqkv, A_wo) + _B_ref(xn, B_w1, B_w2)
```

```asm
; @launch grid=(256,1,1) block=(768,1,1) lds=162048
.amdgcn_target "amdgcn-amd-amdhsa--gfx950"

.text
.globl parallel_sum__sliding_block__dense_activation_relu__prompt_kernel
.p2align 8
.type parallel_sum__sliding_block__dense_activation_relu__prompt_kernel,@function
parallel_sum__sliding_block__dense_activation_relu__prompt_kernel:
  s_cmp_ge_u32 s2, 256
  s_cbranch_scc1 L_END
  s_load_dwordx4 s[4:7], s[0:1], 0
  s_load_dwordx4 s[12:15], s[0:1], 32
  s_load_dwordx2 s[16:17], s[0:1], 64
  s_load_dwordx2 s[8:9], s[0:1], 16
  s_load_dwordx2 s[10:11], s[0:1], 48
  v_lshrrev_b32 v1, 6, v0
  v_and_b32 v0, 63, v0
  v_readfirstlane_b32 s18, v1
  s_bfe_u32 s20, s2, 0x10002
  s_lshl_b32 s20, s20, 3
  s_lshr_b32 s3, s2, 5
  s_add_u32 s20, s20, s3
  s_cmp_ge_u32 s18, 8
  s_cbranch_scc1 L_UTIL
  s_cmp_ge_u32 s18, 4
  s_cbranch_scc1 L_CONS
  v_and_b32 v5, 7, v0
  v_lshrrev_b32 v2, 3, v0
  v_lshrrev_b32 v3, 4, v0
  v_xor_b32 v3, v3, v5
  v_lshlrev_b32 v2, 10, v2
  v_lshl_add_u32 v12, v3, 4, v2
  v_xor_b32 v13, 64, v12
  s_lshl_b32 s65, s20, 17
  s_lshl_b32 s3, s18, 15
  s_add_u32 s65, s65, s3
  s_lshl_b32 s67, s18, 12
  s_mov_b32 s38, 0x200000
  s_mov_b32 s39, 0x20000
  s_waitcnt lgkmcnt(0)
  s_mov_b32 s36, s4
  s_and_b32 s37, s5, 0xffff
  s_add_u32 m0, s67, 49152
  s_add_u32 s74, s65, 0
  buffer_load_dwordx4 v12, s[36:39], s74 offen offset:0  lds
  s_add_u32 s74, s74, 7168
  buffer_load_dwordx4 v13, s[36:39], s74 offen offset:1024  lds
  s_add_u32 s74, s74, 7168
  buffer_load_dwordx4 v12, s[36:39], s74 offen offset:2048  lds
  s_add_u32 s74, s74, 7168
  buffer_load_dwordx4 v13, s[36:39], s74 offen offset:3072  lds
  s_and_b32 s23, s2, 3
  s_lshl_b32 s23, s23, 2
  s_bfe_u32 s3, s2, 0x20003
  s_add_u32 s23, s23, s3
  s_and_b32 s19, s18, 3
  s_xor_b32 s22, s23, 1
  s_mov_b32 s28, s6
  s_and_b32 s29, s7, 0xffff
  s_mov_b32 s30, 0x180000
  s_mov_b32 s31, 0x20000
  s_mov_b32 s32, s12
  s_and_b32 s33, s13, 0xffff
  s_mov_b32 s34, 0x1c0000
  s_mov_b32 s35, 0x20000
  v_lshrrev_b32 v2, 5, v0
  v_bfe_u32 v3, v0, 3, 2
  v_lshl_add_u32 v3, v2, 3, v3
  v_bfe_u32 v4, v0, 4, 2
  v_lshlrev_b32 v4, 1, v4
  v_xor_b32 v4, v4, v5
  v_lshlrev_b32 v4, 4, v4
  v_mul_u32_u24 v10, 3072, v3
  v_add_u32 v10, v10, v4
  v_mul_u32_u24 v11, 3584, v3
  v_add_u32 v11, v11, v4
  s_lshr_b32 s52, s18, 1
  s_lshl_b32 s52, s52, 5
  s_and_b32 s62, s18, 1
  s_lshl_b32 s3, s62, 2
  s_add_u32 s52, s52, s3
  s_lshl_b32 s3, s23, 7
  s_mul_i32 s53, s52, 3072
  s_add_u32 s53, s53, s3
  s_add_u32 s53, s53, 1024
  s_mul_i32 s54, s52, 3584
  s_lshl_b32 s3, s22, 7
  s_add_u32 s54, s54, s3
  s_add_u32 m0, s67, 98304
  s_add_u32 s74, s53, 0
  buffer_load_dwordx4 v10, s[28:31], s74 offen  lds
  s_add_u32 m0, s67, 99328
  s_add_u32 s74, s54, 0
  buffer_load_dwordx4 v11, s[32:35], s74 offen  lds
  s_add_u32 m0, s67, 100352
  s_add_u32 s74, s53, 49152
  buffer_load_dwordx4 v10, s[28:31], s74 offen  lds
  s_add_u32 m0, s67, 101376
  s_add_u32 s74, s54, 57344
  buffer_load_dwordx4 v11, s[32:35], s74 offen  lds
  s_add_u32 m0, s67, 32768
  s_add_u32 s74, s65, 128
  buffer_load_dwordx4 v12, s[36:39], s74 offen offset:0  lds
  s_add_u32 s74, s74, 7168
  buffer_load_dwordx4 v13, s[36:39], s74 offen offset:1024  lds
  s_add_u32 s74, s74, 7168
  buffer_load_dwordx4 v12, s[36:39], s74 offen offset:2048  lds
  s_add_u32 s74, s74, 7168
  buffer_load_dwordx4 v13, s[36:39], s74 offen offset:3072  lds
  s_add_u32 m0, s67, 114688
  s_add_u32 s74, s53, 196608
  buffer_load_dwordx4 v10, s[28:31], s74 offen  lds
  s_add_u32 m0, s67, 115712
  s_add_u32 s74, s54, 229376
  buffer_load_dwordx4 v11, s[32:35], s74 offen  lds
  s_add_u32 m0, s67, 116736
  s_add_u32 s74, s53, 245760
  buffer_load_dwordx4 v10, s[28:31], s74 offen  lds
  s_add_u32 m0, s67, 117760
  s_add_u32 s74, s54, 286720
  buffer_load_dwordx4 v11, s[32:35], s74 offen  lds
  s_add_u32 m0, s67, 131072
  s_add_u32 s74, s65, 256
  buffer_load_dwordx4 v12, s[36:39], s74 offen offset:0  lds
  s_add_u32 s74, s74, 7168
  buffer_load_dwordx4 v13, s[36:39], s74 offen offset:1024  lds
  s_add_u32 s74, s74, 7168
  buffer_load_dwordx4 v12, s[36:39], s74 offen offset:2048  lds
  s_add_u32 s74, s74, 7168
  buffer_load_dwordx4 v13, s[36:39], s74 offen offset:3072  lds
  s_waitcnt vmcnt(12)
  s_barrier
  s_add_u32 m0, s67, 16384
  s_add_u32 s74, s53, 393216
  buffer_load_dwordx4 v10, s[28:31], s74 offen  lds
  s_add_u32 m0, s67, 17408
  s_add_u32 s74, s54, 458752
  buffer_load_dwordx4 v11, s[32:35], s74 offen  lds
  s_add_u32 m0, s67, 18432
  s_add_u32 s74, s53, 442368
  buffer_load_dwordx4 v10, s[28:31], s74 offen  lds
  s_add_u32 m0, s67, 19456
  s_add_u32 s74, s54, 516096
  buffer_load_dwordx4 v11, s[32:35], s74 offen  lds
  s_add_u32 m0, s67, 65536
  s_add_u32 s74, s65, 384
  buffer_load_dwordx4 v12, s[36:39], s74 offen offset:0  lds
  s_add_u32 s74, s74, 7168
  buffer_load_dwordx4 v13, s[36:39], s74 offen offset:1024  lds
  s_add_u32 s74, s74, 7168
  buffer_load_dwordx4 v12, s[36:39], s74 offen offset:2048  lds
  s_add_u32 s74, s74, 7168
  buffer_load_dwordx4 v13, s[36:39], s74 offen offset:3072  lds
  s_waitcnt vmcnt(12)
  s_barrier
  s_add_u32 m0, s67, 0
  s_add_u32 s74, s53, 589824
  buffer_load_dwordx4 v10, s[28:31], s74 offen  lds
  s_add_u32 m0, s67, 1024
  s_add_u32 s74, s54, 688128
  buffer_load_dwordx4 v11, s[32:35], s74 offen  lds
  s_add_u32 m0, s67, 2048
  s_add_u32 s74, s53, 638976
  buffer_load_dwordx4 v10, s[28:31], s74 offen  lds
  s_add_u32 m0, s67, 3072
  s_add_u32 s74, s54, 745472
  buffer_load_dwordx4 v11, s[32:35], s74 offen  lds
  s_add_u32 m0, s67, 81920
  s_add_u32 s74, s65, 512
  buffer_load_dwordx4 v12, s[36:39], s74 offen offset:0  lds
  s_add_u32 s74, s74, 7168
  buffer_load_dwordx4 v13, s[36:39], s74 offen offset:1024  lds
  s_add_u32 s74, s74, 7168
  buffer_load_dwordx4 v12, s[36:39], s74 offen offset:2048  lds
  s_add_u32 s74, s74, 7168
  buffer_load_dwordx4 v13, s[36:39], s74 offen offset:3072  lds
  s_lshl_b32 s24, s20, 4
  s_add_u32 s24, s24, s23
  s_lshl_b32 s24, s24, 7
  s_lshl_b32 s58, s20, 1
  s_lshr_b32 s59, s23, 3
  s_add_u32 s58, s58, s59
  s_and_b32 s59, s23, 7
  s_xor_b32 s59, s59, 2
  s_mov_b32 s40, s16
  s_and_b32 s41, s17, 0xffff
  s_mov_b32 s42, 0x1000000
  s_mov_b32 s43, 0x20000
  s_mov_b32 s44, s14
  s_and_b32 s45, s15, 0xffff
  s_mov_b32 s46, 0x1c0000
  s_mov_b32 s47, 0x20000
  s_mov_b32 s48, s8
  s_and_b32 s49, s9, 0xffff
  s_mov_b32 s50, 0x80000
  s_mov_b32 s51, 0x20000
  v_lshrrev_b32 v8, 3, v0
  v_bfe_u32 v2, v0, 4, 1
  v_lshlrev_b32 v2, 2, v2
  v_xor_b32 v9, v5, v2
  v_lshlrev_b32 v9, 4, v9
  v_lshl_add_u32 v14, v8, 10, v9
  v_lshrrev_b32 v2, 2, v8
  v_lshlrev_b32 v2, 3, v2
  v_and_b32 v8, 3, v8
  v_add_u32 v8, v8, v2
  v_lshl_add_u32 v15, v8, 10, v9
  v_lshlrev_b32 v1, 4, v0
  s_lshl_b32 s3, s59, 7
  s_lshl_b32 s70, s18, 18
  s_add_u32 s70, s70, s3
  s_mul_i32 s78, s18, 196608
  s_add_u32 s78, s78, s3
  s_lshl_b32 s71, s18, 17
  s_add_u32 s71, s71, s3
  s_mul_i32 s72, s58, 229376
  s_add_u32 s72, s72, 0x600000
  s_mul_i32 s79, s18, 12288
  s_add_u32 s79, s79, s72
  s_lshl_b32 s3, s18, 14
  s_add_u32 s72, s72, s3
  s_lshl_b32 s73, s58, 16
  s_lshl_b32 s3, s18, 13
  s_add_u32 s73, s73, s3
  s_add_u32 s73, s73, 0xd00000
  s_and_b32 s3, s58, 3
  s_cmp_eq_u32 s3, s18
  s_cselect_b32 s26, 1, 0
  s_cmp_eq_u32 s59, s18
  s_cselect_b32 s27, 1, 0
  s_add_u32 s3, s18, 4
  s_cmp_eq_u32 s59, s3
  s_cselect_b32 s21, 1, 0
  s_lshl_b32 s69, s58, 1
  s_add_u32 s69, s69, s59
  s_and_b32 s69, s69, 7
  s_sub_u32 s25, s69, 6
  s_cmp_ge_u32 s69, 6
  s_cselect_b32 s25, s25, s69
  s_waitcnt vmcnt(12)
  s_barrier
  s_add_u32 m0, s67, 49152
  s_add_u32 s74, s53, 786432
  buffer_load_dwordx4 v10, s[28:31], s74 offen  lds
  s_add_u32 m0, s67, 50176
  s_add_u32 s74, s54, 917504
  buffer_load_dwordx4 v11, s[32:35], s74 offen  lds
  s_add_u32 m0, s67, 51200
  s_add_u32 s74, s53, 835584
  buffer_load_dwordx4 v10, s[28:31], s74 offen  lds
  s_add_u32 m0, s67, 52224
  s_add_u32 s74, s54, 974848
  buffer_load_dwordx4 v11, s[32:35], s74 offen  lds
  s_add_u32 m0, s67, 98304
  s_add_u32 s74, s65, 640
  buffer_load_dwordx4 v12, s[36:39], s74 offen offset:0  lds
  s_add_u32 s74, s74, 7168
  buffer_load_dwordx4 v13, s[36:39], s74 offen offset:1024  lds
  s_add_u32 s74, s74, 7168
  buffer_load_dwordx4 v12, s[36:39], s74 offen offset:2048  lds
  s_add_u32 s74, s74, 7168
  buffer_load_dwordx4 v13, s[36:39], s74 offen offset:3072  lds
  v_lshrrev_b32 v2, 4, v0
  v_bfe_u32 v3, v0, 2, 2
  v_lshl_add_u32 v3, v2, 3, v3
  v_mul_u32_u24 v16, 3072, v3
  v_and_b32 v2, 1, v2
  v_lshlrev_b32 v2, 1, v2
  v_and_b32 v3, 3, v0
  v_xor_b32 v2, v2, v3
  v_lshl_add_u32 v16, v2, 4, v16
  s_and_b32 s62, s19, 1
  s_lshl_b32 s3, s62, 7
  v_add_u32 v2, s3, v0
  v_add_u32 v2, 0, v2
  v_mul_u32_u24 v3, 10923, v2
  v_lshrrev_b32 v3, 16, v3
  v_mul_u32_u24 v4, 6, v3
  v_sub_u32 v4, v2, v4
  v_bfe_u32 v6, v3, 2, 2
  v_lshlrev_b32 v6, 3, v6
  v_lshrrev_b32 v7, 4, v3
  v_lshl_add_u32 v6, v7, 2, v6
  v_and_b32 v7, 3, v3
  v_add_u32 v6, v6, v7
  v_mul_u32_u24 v17, 3584, v6
  v_lshl_add_u32 v17, v4, 4, v17
  v_add_u32 v2, s3, v0
  v_add_u32 v2, 64, v2
  v_mul_u32_u24 v3, 10923, v2
  v_lshrrev_b32 v3, 16, v3
  v_mul_u32_u24 v4, 6, v3
  v_sub_u32 v4, v2, v4
  v_bfe_u32 v6, v3, 2, 2
  v_lshlrev_b32 v6, 3, v6
  v_lshrrev_b32 v7, 4, v3
  v_lshl_add_u32 v6, v7, 2, v6
  v_and_b32 v7, 3, v3
  v_add_u32 v6, v6, v7
  v_mul_u32_u24 v18, 3584, v6
  v_lshl_add_u32 v18, v4, 4, v18
  s_cmp_eq_u32 s62, 1
  s_cselect_b32 s3, 0x80000000, 0
  v_or_b32 v18, s3, v18
  s_lshr_b32 s3, s19, 1
  s_mul_i32 s55, s52, 3072
  s_lshl_b32 s64, s23, 6
  s_add_u32 s55, s55, s64
  s_mul_i32 s56, s3, 114688
  s_mul_i32 s64, s23, 96
  s_add_u32 s56, s56, s64
  s_add_u32 s56, s56, 2048
  s_mul_i32 s57, s3, 5120
  s_lshl_b32 s64, s62, 10
  s_add_u32 s60, s57, s64
  s_lshl_b32 s64, s62, 11
  s_add_u32 s57, s57, s64
  s_add_u32 s64, s57, 1024
  s_cmp_eq_u32 s62, 1
  s_cselect_b32 s64, 8192, s64
  s_waitcnt vmcnt(12)
  s_barrier
  s_add_u32 m0, s67, 32768
  s_add_u32 s74, s53, 983040
  buffer_load_dwordx4 v10, s[28:31], s74 offen  lds
  s_add_u32 m0, s67, 33792
  s_add_u32 s74, s54, 1146880
  buffer_load_dwordx4 v11, s[32:35], s74 offen  lds
  s_add_u32 m0, s67, 34816
  s_add_u32 s74, s53, 1032192
  buffer_load_dwordx4 v10, s[28:31], s74 offen  lds
  s_add_u32 m0, s67, 35840
  s_add_u32 s74, s54, 1204224
  buffer_load_dwordx4 v11, s[32:35], s74 offen  lds
  s_add_u32 m0, s67, 114688
  s_add_u32 s74, s65, 768
  buffer_load_dwordx4 v12, s[36:39], s74 offen offset:0  lds
  s_add_u32 s74, s74, 7168
  buffer_load_dwordx4 v13, s[36:39], s74 offen offset:1024  lds
  s_add_u32 s74, s74, 7168
  buffer_load_dwordx4 v12, s[36:39], s74 offen offset:2048  lds
  s_add_u32 s74, s74, 7168
  buffer_load_dwordx4 v13, s[36:39], s74 offen offset:3072  lds
  s_waitcnt vmcnt(12)
  s_barrier
  s_add_u32 m0, s67, 16384
  s_add_u32 s74, s53, 1179648
  buffer_load_dwordx4 v10, s[28:31], s74 offen  lds
  s_add_u32 m0, s67, 17408
  s_add_u32 s74, s54, 1376256
  buffer_load_dwordx4 v11, s[32:35], s74 offen  lds
  s_add_u32 m0, s67, 18432
  s_add_u32 s74, s53, 1228800
  buffer_load_dwordx4 v10, s[28:31], s74 offen  lds
  s_add_u32 m0, s67, 19456
  s_add_u32 s74, s54, 1433600
  buffer_load_dwordx4 v11, s[32:35], s74 offen  lds
  s_add_u32 m0, s67, 131072
  s_add_u32 s74, s65, 896
  buffer_load_dwordx4 v12, s[36:39], s74 offen offset:0  lds
  s_add_u32 s74, s74, 7168
  buffer_load_dwordx4 v13, s[36:39], s74 offen offset:1024  lds
  s_add_u32 s74, s74, 7168
  buffer_load_dwordx4 v12, s[36:39], s74 offen offset:2048  lds
  s_add_u32 s74, s74, 7168
  buffer_load_dwordx4 v13, s[36:39], s74 offen offset:3072  lds
  s_waitcnt vmcnt(12)
  s_barrier
  s_add_u32 m0, s67, 0
  s_add_u32 s74, s53, 1376256
  buffer_load_dwordx4 v10, s[28:31], s74 offen  lds
  s_add_u32 m0, s67, 1024
  s_add_u32 s74, s54, 1605632
  buffer_load_dwordx4 v11, s[32:35], s74 offen  lds
  s_add_u32 m0, s67, 2048
  s_add_u32 s74, s53, 1425408
  buffer_load_dwordx4 v10, s[28:31], s74 offen  lds
  s_add_u32 m0, s67, 3072
  s_add_u32 s74, s54, 1662976
  buffer_load_dwordx4 v11, s[32:35], s74 offen  lds
  s_add_u32 m0, s60, 147456
  s_add_u32 s74, s55, 589824
  buffer_load_dwordx4 v16, s[28:31], s74 offen  lds
  s_add_u32 m0, s57, 149504
  s_add_u32 s74, s56, 688128
  buffer_load_dwordx4 v17, s[32:35], s74 offen  lds
  s_add_u32 m0, s64, 149504
  s_nop 0
  buffer_load_dwordx4 v18, s[32:35], s74 offen  lds
  s_waitcnt vmcnt(11)
  s_barrier
  s_add_u32 m0, s60, 54272
  s_add_u32 s74, s55, 786432
  buffer_load_dwordx4 v16, s[28:31], s74 offen  lds
  s_add_u32 m0, s57, 56320
  s_add_u32 s74, s56, 917504
  buffer_load_dwordx4 v17, s[32:35], s74 offen  lds
  s_add_u32 m0, s64, 56320
  s_nop 0
  buffer_load_dwordx4 v18, s[32:35], s74 offen  lds
  s_waitcnt vmcnt(6)
  s_barrier
  s_add_u32 m0, s60, 43008
  s_add_u32 s74, s55, 983040
  buffer_load_dwordx4 v16, s[28:31], s74 offen  lds
  s_add_u32 m0, s57, 45056
  s_add_u32 s74, s56, 1146880
  buffer_load_dwordx4 v17, s[32:35], s74 offen  lds
  s_add_u32 m0, s64, 45056
  s_nop 0
  buffer_load_dwordx4 v18, s[32:35], s74 offen  lds
  v_mov_b32 v2, 161792
  s_mov_b32 s63, 0x400000
LW_1:
  ds_read_b32 v3, v2 offset:28
  s_sub_u32 s63, s63, 1
  s_waitcnt lgkmcnt(0)
  v_readfirstlane_b32 s62, v3
  s_cmp_eq_u32 s63, 0
  s_cbranch_scc1 LWOK_2
  s_cmp_ge_u32 s62, 4
  s_cbranch_scc1 LWOK_2
  s_sleep 1
  s_branch LW_1
LWOK_2:
  s_add_u32 m0, s60, 31744
  s_add_u32 s74, s55, 1179648
  buffer_load_dwordx4 v16, s[28:31], s74 offen  lds
  s_add_u32 m0, s57, 33792
  s_add_u32 s74, s56, 1376256
  buffer_load_dwordx4 v17, s[32:35], s74 offen  lds
  s_add_u32 m0, s64, 33792
  s_nop 0
  buffer_load_dwordx4 v18, s[32:35], s74 offen  lds
  s_add_u32 m0, s60, 20480
  s_add_u32 s74, s55, 1376256
  buffer_load_dwordx4 v16, s[28:31], s74 offen  lds
  s_add_u32 m0, s57, 22528
  s_add_u32 s74, s56, 1605632
  buffer_load_dwordx4 v17, s[32:35], s74 offen  lds
  s_add_u32 m0, s64, 22528
  s_nop 0
  buffer_load_dwordx4 v18, s[32:35], s74 offen  lds
  s_add_u32 m0, s60, 9216
  s_add_u32 s74, s55, 0
  buffer_load_dwordx4 v16, s[28:31], s74 offen  lds
  s_add_u32 m0, s57, 11264
  s_add_u32 s74, s56, 0
  buffer_load_dwordx4 v17, s[32:35], s74 offen  lds
  s_add_u32 m0, s64, 11264
  s_nop 0
  buffer_load_dwordx4 v18, s[32:35], s74 offen  lds
  s_waitcnt vmcnt(0)
  s_barrier
  s_setprio 0
  v_lshrrev_b32 v6, 5, v0
  v_lshlrev_b32 v6, 3, v6
  v_bfe_u32 v7, v0, 2, 2
  v_add_u32 v6, v6, v7
  v_lshlrev_b32 v6, 7, v6
  v_lshrrev_b32 v7, 1, v7
  v_lshl_add_u32 v6, v7, 6, v6
  v_bfe_u32 v7, v0, 4, 1
  v_lshl_add_u32 v6, v7, 5, v6
  v_and_b32 v7, 3, v0
  v_lshl_add_u32 v6, v7, 3, v6
  v_add_u32 v6, s67, v6
  v_xor_b32 v7, 64, v6
  v_add_u32 v8, 49152, v6
  v_add_u32 v9, 49152, v7
  v_add_u32 v10, 98304, v6
  v_add_u32 v11, 98304, v7
  v_mov_b32 v2, 161792
  ds_read_b32 v2, v2
  v_and_b32 v3, 3, v0
  v_lshlrev_b32 v3, 7, v3
  s_lshr_b32 s76, s58, 1
  s_lshl_b32 s76, s76, 11
  s_lshl_b32 s3, s18, 9
  s_add_u32 s76, s76, s3
  s_add_u32 s66, s76, 0xfc0000
  s_mov_b32 s75, 0
  s_waitcnt lgkmcnt(0)
  v_mov_b32 v12, 161792
  s_mov_b32 s63, 0x400000
LW_3:
  ds_read_b32 v13, v12 offset:172
  s_sub_u32 s63, s63, 1
  s_waitcnt lgkmcnt(0)
  v_readfirstlane_b32 s62, v13
  s_cmp_eq_u32 s63, 0
  s_cbranch_scc1 LWOK_4
  s_cmp_ge_u32 s62, 4
  s_cbranch_scc1 LWOK_4
  s_sleep 1
  s_branch LW_3
LWOK_4:
  s_add_u32 m0, s67, 32768
  s_add_u32 s74, s70, 0
  buffer_load_dwordx4 v14, s[44:47], s74 offen lds
  s_add_u32 m0, s67, 33792
  s_add_u32 s74, s70, 8192
  buffer_load_dwordx4 v14, s[44:47], s74 offen lds
  s_add_u32 m0, s67, 34816
  s_add_u32 s74, s70, 16384
  buffer_load_dwordx4 v14, s[44:47], s74 offen lds
  s_add_u32 m0, s67, 35840
  s_add_u32 s74, s70, 24576
  buffer_load_dwordx4 v14, s[44:47], s74 offen lds
  s_add_u32 m0, s67, 114688
  s_add_u32 s74, s70, 32768
  buffer_load_dwordx4 v14, s[44:47], s74 offen lds
  s_add_u32 m0, s67, 115712
  s_add_u32 s74, s70, 40960
  buffer_load_dwordx4 v14, s[44:47], s74 offen lds
  s_add_u32 m0, s67, 116736
  s_add_u32 s74, s70, 49152
  buffer_load_dwordx4 v14, s[44:47], s74 offen lds
  s_add_u32 m0, s67, 117760
  s_add_u32 s74, s70, 57344
  buffer_load_dwordx4 v14, s[44:47], s74 offen lds
  v_mov_b32 v12, 161792
  s_mov_b32 s63, 0x400000
LW_5:
  ds_read_b32 v13, v12 offset:176
  s_sub_u32 s63, s63, 1
  s_waitcnt lgkmcnt(0)
  v_readfirstlane_b32 s62, v13
  s_cmp_eq_u32 s63, 0
  s_cbranch_scc1 LWOK_6
  s_cmp_ge_u32 s62, 4
  s_cbranch_scc1 LWOK_6
  s_sleep 1
  s_branch LW_5
LWOK_6:
  s_add_u32 m0, s67, 131072
  s_add_u32 s74, s70, 65536
  buffer_load_dwordx4 v14, s[44:47], s74 offen lds
  s_add_u32 m0, s67, 132096
  s_add_u32 s74, s70, 73728
  buffer_load_dwordx4 v14, s[44:47], s74 offen lds
  s_add_u32 m0, s67, 133120
  s_add_u32 s74, s70, 81920
  buffer_load_dwordx4 v14, s[44:47], s74 offen lds
  s_add_u32 m0, s67, 134144
  s_add_u32 s74, s70, 90112
  buffer_load_dwordx4 v14, s[44:47], s74 offen lds
  s_mov_b32 s63, 0x40000
POLL_7:
  buffer_load_dword v4, v3, s[40:43], s66 offen sc1
  s_waitcnt vmcnt(0) lgkmcnt(0)
  v_cmp_ne_u32 vcc, v2, v4
  s_sub_u32 s63, s63, 1
  s_cmp_eq_u32 s63, 0
  s_cbranch_scc1 POLLED_8
  s_cmp_lg_u64 vcc, 0
  s_cbranch_scc1 POLL_7
POLLED_8:
  s_add_u32 s74, s72, 0
  buffer_load_dwordx4 v[20:23], v1, s[40:43], s74 offen offset:0 sc1
  buffer_load_dwordx4 v[24:27], v1, s[40:43], s74 offen offset:1024 sc1
  s_add_u32 s74, s72, 114688
  buffer_load_dwordx4 v[28:31], v1, s[40:43], s74 offen offset:0 sc1
  buffer_load_dwordx4 v[32:35], v1, s[40:43], s74 offen offset:1024 sc1
  s_add_u32 s74, s72, 2048
  buffer_load_dwordx4 v[36:39], v1, s[40:43], s74 offen offset:0 sc1
  buffer_load_dwordx4 v[40:43], v1, s[40:43], s74 offen offset:1024 sc1
  s_add_u32 s74, s72, 116736
  buffer_load_dwordx4 v[44:47], v1, s[40:43], s74 offen offset:0 sc1
  buffer_load_dwordx4 v[48:51], v1, s[40:43], s74 offen offset:1024 sc1
  s_add_u32 s74, s72, 4096
  buffer_load_dwordx4 v[52:55], v1, s[40:43], s74 offen offset:0 sc1
  buffer_load_dwordx4 v[56:59], v1, s[40:43], s74 offen offset:1024 sc1
  s_add_u32 s74, s72, 118784
  buffer_load_dwordx4 v[60:63], v1, s[40:43], s74 offen offset:0 sc1
  buffer_load_dwordx4 v[64:67], v1, s[40:43], s74 offen offset:1024 sc1
  v_mov_b32 v12, 161792
  s_mov_b32 s63, 0x400000
LW_9:
  ds_read_b32 v13, v12 offset:180
  s_sub_u32 s63, s63, 1
  s_waitcnt lgkmcnt(0)
  v_readfirstlane_b32 s62, v13
  s_cmp_eq_u32 s63, 0
  s_cbranch_scc1 LWOK_10
  s_cmp_ge_u32 s62, 4
  s_cbranch_scc1 LWOK_10
  s_sleep 1
  s_branch LW_9
LWOK_10:
  s_add_u32 m0, s67, 0
  s_add_u32 s74, s70, 98304
  buffer_load_dwordx4 v14, s[44:47], s74 offen lds
  s_add_u32 m0, s67, 1024
  s_add_u32 s74, s70, 106496
  buffer_load_dwordx4 v14, s[44:47], s74 offen lds
  s_add_u32 m0, s67, 2048
  s_add_u32 s74, s70, 114688
  buffer_load_dwordx4 v14, s[44:47], s74 offen lds
  s_add_u32 m0, s67, 3072
  s_add_u32 s74, s70, 122880
  buffer_load_dwordx4 v14, s[44:47], s74 offen lds
  s_waitcnt vmcnt(12)
  ds_read_b64_tr_b16 v[148:149], v6 offset:32768
  ds_read_b64_tr_b16 v[150:151], v6 offset:33280
  ds_read_b64_tr_b16 v[152:153], v7 offset:32768
  ds_read_b64_tr_b16 v[154:155], v7 offset:33280
  ds_read_b64_tr_b16 v[156:157], v6 offset:34816
  ds_read_b64_tr_b16 v[158:159], v6 offset:35328
  ds_read_b64_tr_b16 v[160:161], v7 offset:34816
  ds_read_b64_tr_b16 v[162:163], v7 offset:35328
  s_add_u32 s74, s72, 6144
  buffer_load_dwordx4 v[68:71], v1, s[40:43], s74 offen offset:0 sc1
  buffer_load_dwordx4 v[72:75], v1, s[40:43], s74 offen offset:1024 sc1
  s_add_u32 s74, s72, 120832
  buffer_load_dwordx4 v[76:79], v1, s[40:43], s74 offen offset:0 sc1
  buffer_load_dwordx4 v[80:83], v1, s[40:43], s74 offen offset:1024 sc1
  s_waitcnt lgkmcnt(6)
  v_mfma_f32_32x32x16_bf16 v[84:99], v[148:151], v[20:23], 0
  v_mfma_f32_32x32x16_bf16 v[116:131], v[148:151], v[28:31], 0
  s_waitcnt lgkmcnt(4)
  v_mfma_f32_32x32x16_bf16 v[100:115], v[152:155], v[20:23], 0
  v_mfma_f32_32x32x16_bf16 v[132:147], v[152:155], v[28:31], 0
  s_waitcnt lgkmcnt(2)
  v_mfma_f32_32x32x16_bf16 v[84:99], v[156:159], v[24:27], v[84:99]
  v_mfma_f32_32x32x16_bf16 v[116:131], v[156:159], v[32:35], v[116:131]
  s_waitcnt lgkmcnt(0)
  v_mfma_f32_32x32x16_bf16 v[100:115], v[160:163], v[24:27], v[100:115]
  v_mfma_f32_32x32x16_bf16 v[132:147], v[160:163], v[32:35], v[132:147]
  s_add_u32 m0, s67, 16384
  s_add_u32 s74, s70, 131072
  buffer_load_dwordx4 v14, s[44:47], s74 offen lds
  s_add_u32 m0, s67, 17408
  s_add_u32 s74, s70, 139264
  buffer_load_dwordx4 v14, s[44:47], s74 offen lds
  s_add_u32 m0, s67, 18432
  s_add_u32 s74, s70, 147456
  buffer_load_dwordx4 v14, s[44:47], s74 offen lds
  s_add_u32 m0, s67, 19456
  s_add_u32 s74, s70, 155648
  buffer_load_dwordx4 v14, s[44:47], s74 offen lds
  s_waitcnt vmcnt(16)
  ds_read_b64_tr_b16 v[148:149], v10 offset:16384
  ds_read_b64_tr_b16 v[150:151], v10 offset:16896
  ds_read_b64_tr_b16 v[152:153], v11 offset:16384
  ds_read_b64_tr_b16 v[154:155], v11 offset:16896
  ds_read_b64_tr_b16 v[156:157], v10 offset:18432
  ds_read_b64_tr_b16 v[158:159], v10 offset:18944
  ds_read_b64_tr_b16 v[160:161], v11 offset:18432
  ds_read_b64_tr_b16 v[162:163], v11 offset:18944
  s_add_u32 m0, s67, 32768
  s_add_u32 s74, s70, 196608
  buffer_load_dwordx4 v14, s[44:47], s74 offen lds
  s_add_u32 m0, s67, 33792
  s_add_u32 s74, s70, 204800
  buffer_load_dwordx4 v14, s[44:47], s74 offen lds
  s_add_u32 m0, s67, 34816
  s_add_u32 s74, s70, 212992
  buffer_load_dwordx4 v14, s[44:47], s74 offen lds
  s_add_u32 m0, s67, 35840
  s_add_u32 s74, s70, 221184
  buffer_load_dwordx4 v14, s[44:47], s74 offen lds
  s_add_u32 s74, s72, 8192
  buffer_load_dwordx4 v[20:23], v1, s[40:43], s74 offen offset:0 sc1
  buffer_load_dwordx4 v[24:27], v1, s[40:43], s74 offen offset:1024 sc1
  s_add_u32 s74, s72, 122880
  buffer_load_dwordx4 v[28:31], v1, s[40:43], s74 offen offset:0 sc1
  buffer_load_dwordx4 v[32:35], v1, s[40:43], s74 offen offset:1024 sc1
  s_waitcnt lgkmcnt(6)
  v_mfma_f32_32x32x16_bf16 v[84:99], v[148:151], v[36:39], v[84:99]
  v_mfma_f32_32x32x16_bf16 v[116:131], v[148:151], v[44:47], v[116:131]
  s_waitcnt lgkmcnt(4)
  v_mfma_f32_32x32x16_bf16 v[100:115], v[152:155], v[36:39], v[100:115]
  v_mfma_f32_32x32x16_bf16 v[132:147], v[152:155], v[44:47], v[132:147]
  s_waitcnt lgkmcnt(2)
  v_mfma_f32_32x32x16_bf16 v[84:99], v[156:159], v[40:43], v[84:99]
  v_mfma_f32_32x32x16_bf16 v[116:131], v[156:159], v[48:51], v[116:131]
  s_waitcnt lgkmcnt(0)
  v_mfma_f32_32x32x16_bf16 v[100:115], v[160:163], v[40:43], v[100:115]
  v_mfma_f32_32x32x16_bf16 v[132:147], v[160:163], v[48:51], v[132:147]
  v_mov_b32 v12, 161792
  s_mov_b32 s63, 0x400000
LW_11:
  ds_read_b32 v13, v12 offset:188
  s_sub_u32 s63, s63, 1
  s_waitcnt lgkmcnt(0)
  v_readfirstlane_b32 s62, v13
  s_cmp_eq_u32 s63, 0
  s_cbranch_scc1 LWOK_12
  s_cmp_ge_u32 s62, 4
  s_cbranch_scc1 LWOK_12
  s_sleep 1
  s_branch LW_11
LWOK_12:
  s_add_u32 m0, s67, 49152
  s_add_u32 s74, s70, 163840
  buffer_load_dwordx4 v14, s[44:47], s74 offen lds
  s_add_u32 m0, s67, 50176
  s_add_u32 s74, s70, 172032
  buffer_load_dwordx4 v14, s[44:47], s74 offen lds
  s_add_u32 m0, s67, 51200
  s_add_u32 s74, s70, 180224
  buffer_load_dwordx4 v14, s[44:47], s74 offen lds
  s_add_u32 m0, s67, 52224
  s_add_u32 s74, s70, 188416
  buffer_load_dwordx4 v14, s[44:47], s74 offen lds
  s_waitcnt vmcnt(24)
  ds_read_b64_tr_b16 v[148:149], v10 offset:32768
  ds_read_b64_tr_b16 v[150:151], v10 offset:33280
  ds_read_b64_tr_b16 v[152:153], v11 offset:32768
  ds_read_b64_tr_b16 v[154:155], v11 offset:33280
  ds_read_b64_tr_b16 v[156:157], v10 offset:34816
  ds_read_b64_tr_b16 v[158:159], v10 offset:35328
  ds_read_b64_tr_b16 v[160:161], v11 offset:34816
  ds_read_b64_tr_b16 v[162:163], v11 offset:35328
  s_add_u32 m0, s67, 114688
  s_add_u32 s74, s70, 229376
  buffer_load_dwordx4 v14, s[44:47], s74 offen lds
  s_add_u32 m0, s67, 115712
  s_add_u32 s74, s70, 237568
  buffer_load_dwordx4 v14, s[44:47], s74 offen lds
  s_add_u32 m0, s67, 116736
  s_add_u32 s74, s70, 245760
  buffer_load_dwordx4 v14, s[44:47], s74 offen lds
  s_add_u32 m0, s67, 117760
  s_add_u32 s74, s70, 253952
  buffer_load_dwordx4 v14, s[44:47], s74 offen lds
  s_add_u32 s74, s72, 10240
  buffer_load_dwordx4 v[36:39], v1, s[40:43], s74 offen offset:0 sc1
  buffer_load_dwordx4 v[40:43], v1, s[40:43], s74 offen offset:1024 sc1
  s_add_u32 s74, s72, 124928
  buffer_load_dwordx4 v[44:47], v1, s[40:43], s74 offen offset:0 sc1
  buffer_load_dwordx4 v[48:51], v1, s[40:43], s74 offen offset:1024 sc1
  s_waitcnt lgkmcnt(6)
  v_mfma_f32_32x32x16_bf16 v[84:99], v[148:151], v[52:55], v[84:99]
  v_mfma_f32_32x32x16_bf16 v[116:131], v[148:151], v[60:63], v[116:131]
  s_waitcnt lgkmcnt(4)
  v_mfma_f32_32x32x16_bf16 v[100:115], v[152:155], v[52:55], v[100:115]
  v_mfma_f32_32x32x16_bf16 v[132:147], v[152:155], v[60:63], v[132:147]
  s_waitcnt lgkmcnt(2)
  v_mfma_f32_32x32x16_bf16 v[84:99], v[156:159], v[56:59], v[84:99]
  v_mfma_f32_32x32x16_bf16 v[116:131], v[156:159], v[64:67], v[116:131]
  s_waitcnt lgkmcnt(0)
  v_mfma_f32_32x32x16_bf16 v[100:115], v[160:163], v[56:59], v[100:115]
  v_mfma_f32_32x32x16_bf16 v[132:147], v[160:163], v[64:67], v[132:147]
  s_add_u32 s66, s76, 0xfa0000
  buffer_load_dword v4, v3, s[40:43], s66 offen sc1
  s_waitcnt vmcnt(25)
  ds_read_b64_tr_b16 v[148:149], v6 offset:0
  ds_read_b64_tr_b16 v[150:151], v6 offset:512
  ds_read_b64_tr_b16 v[152:153], v7 offset:0
  ds_read_b64_tr_b16 v[154:155], v7 offset:512
  ds_read_b64_tr_b16 v[156:157], v6 offset:2048
  ds_read_b64_tr_b16 v[158:159], v6 offset:2560
  ds_read_b64_tr_b16 v[160:161], v7 offset:2048
  ds_read_b64_tr_b16 v[162:163], v7 offset:2560
  s_add_u32 m0, s67, 131072
  s_add_u32 s74, s78, 1048576
  buffer_load_dwordx4 v14, s[44:47], s74 offen lds
  s_add_u32 m0, s67, 132096
  s_add_u32 s74, s78, 1056768
  buffer_load_dwordx4 v14, s[44:47], s74 offen lds
  s_add_u32 m0, s67, 133120
  s_add_u32 s74, s78, 1064960
  buffer_load_dwordx4 v14, s[44:47], s74 offen lds
  s_add_u32 m0, s67, 134144
  s_add_u32 s74, s78, 1073152
  buffer_load_dwordx4 v14, s[44:47], s74 offen lds
  s_add_u32 s74, s72, 12288
  buffer_load_dwordx4 v[52:55], v1, s[40:43], s74 offen offset:0 sc1
  buffer_load_dwordx4 v[56:59], v1, s[40:43], s74 offen offset:1024 sc1
  s_add_u32 s74, s72, 126976
  buffer_load_dwordx4 v[60:63], v1, s[40:43], s74 offen offset:0 sc1
  buffer_load_dwordx4 v[64:67], v1, s[40:43], s74 offen offset:1024 sc1
  s_waitcnt lgkmcnt(6)
  v_mfma_f32_32x32x16_bf16 v[84:99], v[148:151], v[68:71], v[84:99]
  v_mfma_f32_32x32x16_bf16 v[116:131], v[148:151], v[76:79], v[116:131]
  s_waitcnt lgkmcnt(4)
  v_mfma_f32_32x32x16_bf16 v[100:115], v[152:155], v[68:71], v[100:115]
  v_mfma_f32_32x32x16_bf16 v[132:147], v[152:155], v[76:79], v[132:147]
  s_waitcnt lgkmcnt(2)
  v_mfma_f32_32x32x16_bf16 v[84:99], v[156:159], v[72:75], v[84:99]
  v_mfma_f32_32x32x16_bf16 v[116:131], v[156:159], v[80:83], v[116:131]
  s_waitcnt lgkmcnt(0)
  v_mfma_f32_32x32x16_bf16 v[100:115], v[160:163], v[72:75], v[100:115]
  v_mfma_f32_32x32x16_bf16 v[132:147], v[160:163], v[80:83], v[132:147]
  s_waitcnt vmcnt(21)
  ds_read_b64_tr_b16 v[148:149], v6 offset:16384
  ds_read_b64_tr_b16 v[150:151], v6 offset:16896
  ds_read_b64_tr_b16 v[152:153], v7 offset:16384
  ds_read_b64_tr_b16 v[154:155], v7 offset:16896
  ds_read_b64_tr_b16 v[156:157], v6 offset:18432
  ds_read_b64_tr_b16 v[158:159], v6 offset:18944
  ds_read_b64_tr_b16 v[160:161], v7 offset:18432
  ds_read_b64_tr_b16 v[162:163], v7 offset:18944
  s_add_u32 m0, s67, 0
  s_add_u32 s74, s78, 1081344
  buffer_load_dwordx4 v14, s[44:47], s74 offen lds
  s_add_u32 m0, s67, 1024
  s_add_u32 s74, s78, 1089536
  buffer_load_dwordx4 v14, s[44:47], s74 offen lds
  s_add_u32 m0, s67, 2048
  s_add_u32 s74, s78, 1097728
  buffer_load_dwordx4 v14, s[44:47], s74 offen lds
  s_add_u32 m0, s67, 3072
  s_add_u32 s74, s78, 1105920
  buffer_load_dwordx4 v14, s[44:47], s74 offen lds
  s_add_u32 s74, s72, 14336
  buffer_load_dwordx4 v[68:71], v1, s[40:43], s74 offen offset:0 sc1
  buffer_load_dwordx4 v[72:75], v1, s[40:43], s74 offen offset:1024 sc1
  s_add_u32 s74, s72, 129024
  buffer_load_dwordx4 v[76:79], v1, s[40:43], s74 offen offset:0 sc1
  buffer_load_dwordx4 v[80:83], v1, s[40:43], s74 offen offset:1024 sc1
  s_waitcnt lgkmcnt(6)
  v_mfma_f32_32x32x16_bf16 v[84:99], v[148:151], v[20:23], v[84:99]
  v_mfma_f32_32x32x16_bf16 v[116:131], v[148:151], v[28:31], v[116:131]
  s_waitcnt lgkmcnt(4)
  v_mfma_f32_32x32x16_bf16 v[100:115], v[152:155], v[20:23], v[100:115]
  v_mfma_f32_32x32x16_bf16 v[132:147], v[152:155], v[28:31], v[132:147]
  s_waitcnt lgkmcnt(2)
  v_mfma_f32_32x32x16_bf16 v[84:99], v[156:159], v[24:27], v[84:99]
  v_mfma_f32_32x32x16_bf16 v[116:131], v[156:159], v[32:35], v[116:131]
  s_waitcnt lgkmcnt(0)
  v_mfma_f32_32x32x16_bf16 v[100:115], v[160:163], v[24:27], v[100:115]
  v_mfma_f32_32x32x16_bf16 v[132:147], v[160:163], v[32:35], v[132:147]
  s_waitcnt vmcnt(16)
  v_cmp_ne_u32 vcc, v2, v4
  s_nop 1
  s_cmp_eq_u64 vcc, 0
  s_cbranch_scc1 AOK_13
  s_mov_b32 s63, 0x40000
POLL_14:
  buffer_load_dword v4, v3, s[40:43], s66 offen sc1
  s_waitcnt vmcnt(0) lgkmcnt(0)
  v_cmp_ne_u32 vcc, v2, v4
  s_sub_u32 s63, s63, 1
  s_cmp_eq_u32 s63, 0
  s_cbranch_scc1 POLLED_15
  s_cmp_lg_u64 vcc, 0
  s_cbranch_scc1 POLL_14
POLLED_15:
AOK_13:
  ds_read_b64_tr_b16 v[148:149], v8 offset:0
  ds_read_b64_tr_b16 v[150:151], v8 offset:512
  ds_read_b64_tr_b16 v[152:153], v9 offset:0
  ds_read_b64_tr_b16 v[154:155], v9 offset:512
  ds_read_b64_tr_b16 v[156:157], v8 offset:2048
  ds_read_b64_tr_b16 v[158:159], v8 offset:2560
  ds_read_b64_tr_b16 v[160:161], v9 offset:2048
  ds_read_b64_tr_b16 v[162:163], v9 offset:2560
  s_add_u32 m0, s67, 16384
  s_add_u32 s74, s78, 1114112
  buffer_load_dwordx4 v14, s[44:47], s74 offen lds
  s_add_u32 m0, s67, 17408
  s_add_u32 s74, s78, 1122304
  buffer_load_dwordx4 v14, s[44:47], s74 offen lds
  s_add_u32 m0, s67, 18432
  s_add_u32 s74, s78, 1130496
  buffer_load_dwordx4 v14, s[44:47], s74 offen lds
  s_add_u32 m0, s67, 19456
  s_add_u32 s74, s78, 1138688
  buffer_load_dwordx4 v14, s[44:47], s74 offen lds
  s_add_u32 s74, s79, 65536
  buffer_load_dwordx4 v[20:23], v1, s[40:43], s74 offen offset:0 sc1
  buffer_load_dwordx4 v[24:27], v1, s[40:43], s74 offen offset:1024 sc1
  s_add_u32 s74, s79, 180224
  buffer_load_dwordx4 v[28:31], v1, s[40:43], s74 offen offset:0 sc1
  buffer_load_dwordx4 v[32:35], v1, s[40:43], s74 offen offset:1024 sc1
  s_waitcnt lgkmcnt(6)
  v_mfma_f32_32x32x16_bf16 v[84:99], v[148:151], v[36:39], v[84:99]
  v_mfma_f32_32x32x16_bf16 v[116:131], v[148:151], v[44:47], v[116:131]
  s_waitcnt lgkmcnt(4)
  v_mfma_f32_32x32x16_bf16 v[100:115], v[152:155], v[36:39], v[100:115]
  v_mfma_f32_32x32x16_bf16 v[132:147], v[152:155], v[44:47], v[132:147]
  s_waitcnt lgkmcnt(2)
  v_mfma_f32_32x32x16_bf16 v[84:99], v[156:159], v[40:43], v[84:99]
  v_mfma_f32_32x32x16_bf16 v[116:131], v[156:159], v[48:51], v[116:131]
  s_waitcnt lgkmcnt(0)
  v_mfma_f32_32x32x16_bf16 v[100:115], v[160:163], v[40:43], v[100:115]
  v_mfma_f32_32x32x16_bf16 v[132:147], v[160:163], v[48:51], v[132:147]
  s_waitcnt vmcnt(16)
  ds_read_b64_tr_b16 v[148:149], v6 offset:32768
  ds_read_b64_tr_b16 v[150:151], v6 offset:33280
  ds_read_b64_tr_b16 v[152:153], v7 offset:32768
  ds_read_b64_tr_b16 v[154:155], v7 offset:33280
  ds_read_b64_tr_b16 v[156:157], v6 offset:34816
  ds_read_b64_tr_b16 v[158:159], v6 offset:35328
  ds_read_b64_tr_b16 v[160:161], v7 offset:34816
  ds_read_b64_tr_b16 v[162:163], v7 offset:35328
  s_add_u32 m0, s67, 49152
  s_add_u32 s74, s78, 1146880
  buffer_load_dwordx4 v14, s[44:47], s74 offen lds
  s_add_u32 m0, s67, 50176
  s_add_u32 s74, s78, 1155072
  buffer_load_dwordx4 v14, s[44:47], s74 offen lds
  s_add_u32 m0, s67, 51200
  s_add_u32 s74, s78, 1163264
  buffer_load_dwordx4 v14, s[44:47], s74 offen lds
  s_add_u32 m0, s67, 52224
  s_add_u32 s74, s78, 1171456
  buffer_load_dwordx4 v14, s[44:47], s74 offen lds
  s_add_u32 s74, s79, 67584
  buffer_load_dwordx4 v[36:39], v1, s[40:43], s74 offen offset:0 sc1
  buffer_load_dwordx4 v[40:43], v1, s[40:43], s74 offen offset:1024 sc1
  s_add_u32 s74, s79, 182272
  buffer_load_dwordx4 v[44:47], v1, s[40:43], s74 offen offset:0 sc1
  buffer_load_dwordx4 v[48:51], v1, s[40:43], s74 offen offset:1024 sc1
  s_waitcnt lgkmcnt(6)
  v_mfma_f32_32x32x16_bf16 v[84:99], v[148:151], v[52:55], v[84:99]
  v_mfma_f32_32x32x16_bf16 v[116:131], v[148:151], v[60:63], v[116:131]
  ds_read_b64_tr_b16 v[148:149], v10 offset:16384
  ds_read_b64_tr_b16 v[150:151], v10 offset:16896
  s_waitcnt lgkmcnt(6)
  v_mfma_f32_32x32x16_bf16 v[100:115], v[152:155], v[52:55], v[100:115]
  v_mfma_f32_32x32x16_bf16 v[132:147], v[152:155], v[60:63], v[132:147]
  ds_read_b64_tr_b16 v[152:153], v11 offset:16384
  ds_read_b64_tr_b16 v[154:155], v11 offset:16896
  s_waitcnt lgkmcnt(6)
  v_mfma_f32_32x32x16_bf16 v[84:99], v[156:159], v[56:59], v[84:99]
  v_mfma_f32_32x32x16_bf16 v[116:131], v[156:159], v[64:67], v[116:131]
  ds_read_b64_tr_b16 v[156:157], v10 offset:18432
  ds_read_b64_tr_b16 v[158:159], v10 offset:18944
  s_waitcnt lgkmcnt(6)
  v_mfma_f32_32x32x16_bf16 v[100:115], v[160:163], v[56:59], v[100:115]
  v_mfma_f32_32x32x16_bf16 v[132:147], v[160:163], v[64:67], v[132:147]
  ds_read_b64_tr_b16 v[160:161], v11 offset:18432
  ds_read_b64_tr_b16 v[162:163], v11 offset:18944
  s_waitcnt vmcnt(16)
  s_add_u32 m0, s67, 32768
  s_add_u32 s74, s78, 1179648
  buffer_load_dwordx4 v14, s[44:47], s74 offen lds
  s_add_u32 m0, s67, 33792
  s_add_u32 s74, s78, 1187840
  buffer_load_dwordx4 v14, s[44:47], s74 offen lds
  s_add_u32 m0, s67, 34816
  s_add_u32 s74, s78, 1196032
  buffer_load_dwordx4 v14, s[44:47], s74 offen lds
  s_add_u32 m0, s67, 35840
  s_add_u32 s74, s78, 1204224
  buffer_load_dwordx4 v14, s[44:47], s74 offen lds
  s_add_u32 s74, s79, 69632
  buffer_load_dwordx4 v[52:55], v1, s[40:43], s74 offen offset:0 sc1
  buffer_load_dwordx4 v[56:59], v1, s[40:43], s74 offen offset:1024 sc1
  s_add_u32 s74, s79, 184320
  buffer_load_dwordx4 v[60:63], v1, s[40:43], s74 offen offset:0 sc1
  buffer_load_dwordx4 v[64:67], v1, s[40:43], s74 offen offset:1024 sc1
  s_waitcnt lgkmcnt(6)
  v_mfma_f32_32x32x16_bf16 v[84:99], v[148:151], v[68:71], v[84:99]
  v_mfma_f32_32x32x16_bf16 v[116:131], v[148:151], v[76:79], v[116:131]
  ds_read_b64_tr_b16 v[148:149], v10 offset:32768
  ds_read_b64_tr_b16 v[150:151], v10 offset:33280
  s_waitcnt lgkmcnt(6)
  v_mfma_f32_32x32x16_bf16 v[100:115], v[152:155], v[68:71], v[100:115]
  v_mfma_f32_32x32x16_bf16 v[132:147], v[152:155], v[76:79], v[132:147]
  ds_read_b64_tr_b16 v[152:153], v11 offset:32768
  ds_read_b64_tr_b16 v[154:155], v11 offset:33280
  s_waitcnt lgkmcnt(6)
  v_mfma_f32_32x32x16_bf16 v[84:99], v[156:159], v[72:75], v[84:99]
  v_mfma_f32_32x32x16_bf16 v[116:131], v[156:159], v[80:83], v[116:131]
  ds_read_b64_tr_b16 v[156:157], v10 offset:34816
  ds_read_b64_tr_b16 v[158:159], v10 offset:35328
  s_waitcnt lgkmcnt(6)
  v_mfma_f32_32x32x16_bf16 v[100:115], v[160:163], v[72:75], v[100:115]
  v_mfma_f32_32x32x16_bf16 v[132:147], v[160:163], v[80:83], v[132:147]
  ds_read_b64_tr_b16 v[160:161], v11 offset:34816
  ds_read_b64_tr_b16 v[162:163], v11 offset:35328
  s_waitcnt vmcnt(16)
  s_add_u32 m0, s67, 114688
  s_add_u32 s74, s78, 1212416
  buffer_load_dwordx4 v14, s[44:47], s74 offen lds
  s_add_u32 m0, s67, 115712
  s_add_u32 s74, s78, 1220608
  buffer_load_dwordx4 v14, s[44:47], s74 offen lds
  s_add_u32 m0, s67, 116736
  s_add_u32 s74, s78, 1228800
  buffer_load_dwordx4 v14, s[44:47], s74 offen lds
  s_add_u32 m0, s67, 117760
  s_add_u32 s74, s78, 1236992
  buffer_load_dwordx4 v14, s[44:47], s74 offen lds
  s_add_u32 s74, s79, 71680
  buffer_load_dwordx4 v[68:71], v1, s[40:43], s74 offen offset:0 sc1
  buffer_load_dwordx4 v[72:75], v1, s[40:43], s74 offen offset:1024 sc1
  s_add_u32 s74, s79, 186368
  buffer_load_dwordx4 v[76:79], v1, s[40:43], s74 offen offset:0 sc1
  buffer_load_dwordx4 v[80:83], v1, s[40:43], s74 offen offset:1024 sc1
  s_waitcnt lgkmcnt(6)
  v_mfma_f32_32x32x16_bf16 v[84:99], v[148:151], v[20:23], v[84:99]
  v_mfma_f32_32x32x16_bf16 v[116:131], v[148:151], v[28:31], v[116:131]
  ds_read_b64_tr_b16 v[148:149], v6 offset:0
  ds_read_b64_tr_b16 v[150:151], v6 offset:512
  s_waitcnt lgkmcnt(6)
  v_mfma_f32_32x32x16_bf16 v[100:115], v[152:155], v[20:23], v[100:115]
  v_mfma_f32_32x32x16_bf16 v[132:147], v[152:155], v[28:31], v[132:147]
  ds_read_b64_tr_b16 v[152:153], v7 offset:0
  ds_read_b64_tr_b16 v[154:155], v7 offset:512
  s_waitcnt lgkmcnt(6)
  v_mfma_f32_32x32x16_bf16 v[84:99], v[156:159], v[24:27], v[84:99]
  v_mfma_f32_32x32x16_bf16 v[116:131], v[156:159], v[32:35], v[116:131]
  ds_read_b64_tr_b16 v[156:157], v6 offset:2048
  ds_read_b64_tr_b16 v[158:159], v6 offset:2560
  s_waitcnt lgkmcnt(6)
  v_mfma_f32_32x32x16_bf16 v[100:115], v[160:163], v[24:27], v[100:115]
  v_mfma_f32_32x32x16_bf16 v[132:147], v[160:163], v[32:35], v[132:147]
  ds_read_b64_tr_b16 v[160:161], v7 offset:2048
  ds_read_b64_tr_b16 v[162:163], v7 offset:2560
  s_waitcnt vmcnt(16)
  s_add_u32 m0, s67, 131072
  s_add_u32 s74, s71, 0
  buffer_load_dwordx4 v15, s[48:51], s74 offen lds
  s_add_u32 m0, s67, 132096
  s_add_u32 s74, s71, 4096
  buffer_load_dwordx4 v15, s[48:51], s74 offen lds
  s_add_u32 m0, s67, 133120
  s_add_u32 s74, s71, 16384
  buffer_load_dwordx4 v15, s[48:51], s74 offen lds
  s_add_u32 m0, s67, 134144
  s_add_u32 s74, s71, 20480
  buffer_load_dwordx4 v15, s[48:51], s74 offen lds
  s_add_u32 s74, s79, 73728
  buffer_load_dwordx4 v[20:23], v1, s[40:43], s74 offen offset:0 sc1
  buffer_load_dwordx4 v[24:27], v1, s[40:43], s74 offen offset:1024 sc1
  s_add_u32 s74, s79, 188416
  buffer_load_dwordx4 v[28:31], v1, s[40:43], s74 offen offset:0 sc1
  buffer_load_dwordx4 v[32:35], v1, s[40:43], s74 offen offset:1024 sc1
  s_waitcnt lgkmcnt(6)
  v_mfma_f32_32x32x16_bf16 v[84:99], v[148:151], v[36:39], v[84:99]
  v_mfma_f32_32x32x16_bf16 v[116:131], v[148:151], v[44:47], v[116:131]
  ds_read_b64_tr_b16 v[148:149], v6 offset:16384
  ds_read_b64_tr_b16 v[150:151], v6 offset:16896
  s_waitcnt lgkmcnt(6)
  v_mfma_f32_32x32x16_bf16 v[100:115], v[152:155], v[36:39], v[100:115]
  v_mfma_f32_32x32x16_bf16 v[132:147], v[152:155], v[44:47], v[132:147]
  ds_read_b64_tr_b16 v[152:153], v7 offset:16384
  ds_read_b64_tr_b16 v[154:155], v7 offset:16896
  s_waitcnt lgkmcnt(6)
  v_mfma_f32_32x32x16_bf16 v[84:99], v[156:159], v[40:43], v[84:99]
  v_mfma_f32_32x32x16_bf16 v[116:131], v[156:159], v[48:51], v[116:131]
  ds_read_b64_tr_b16 v[156:157], v6 offset:18432
  ds_read_b64_tr_b16 v[158:159], v6 offset:18944
  s_waitcnt lgkmcnt(6)
  v_mfma_f32_32x32x16_bf16 v[100:115], v[160:163], v[40:43], v[100:115]
  v_mfma_f32_32x32x16_bf16 v[132:147], v[160:163], v[48:51], v[132:147]
  ds_read_b64_tr_b16 v[160:161], v7 offset:18432
  ds_read_b64_tr_b16 v[162:163], v7 offset:18944
  s_waitcnt vmcnt(16)
  s_add_u32 m0, s67, 0
  s_add_u32 s74, s71, 32768
  buffer_load_dwordx4 v15, s[48:51], s74 offen lds
  s_add_u32 m0, s67, 1024
  s_add_u32 s74, s71, 36864
  buffer_load_dwordx4 v15, s[48:51], s74 offen lds
  s_add_u32 m0, s67, 2048
  s_add_u32 s74, s71, 49152
  buffer_load_dwordx4 v15, s[48:51], s74 offen lds
  s_add_u32 m0, s67, 3072
  s_add_u32 s74, s71, 53248
  buffer_load_dwordx4 v15, s[48:51], s74 offen lds
  s_add_u32 s74, s79, 75776
  buffer_load_dwordx4 v[36:39], v1, s[40:43], s74 offen offset:0 sc1
  buffer_load_dwordx4 v[40:43], v1, s[40:43], s74 offen offset:1024 sc1
  s_add_u32 s74, s79, 190464
  buffer_load_dwordx4 v[44:47], v1, s[40:43], s74 offen offset:0 sc1
  buffer_load_dwordx4 v[48:51], v1, s[40:43], s74 offen offset:1024 sc1
  s_waitcnt lgkmcnt(6)
  v_mfma_f32_32x32x16_bf16 v[84:99], v[148:151], v[52:55], v[84:99]
  v_mfma_f32_32x32x16_bf16 v[116:131], v[148:151], v[60:63], v[116:131]
  ds_read_b64_tr_b16 v[148:149], v8 offset:0
  ds_read_b64_tr_b16 v[150:151], v8 offset:512
  s_waitcnt lgkmcnt(6)
  v_mfma_f32_32x32x16_bf16 v[100:115], v[152:155], v[52:55], v[100:115]
  v_mfma_f32_32x32x16_bf16 v[132:147], v[152:155], v[60:63], v[132:147]
  ds_read_b64_tr_b16 v[152:153], v9 offset:0
  ds_read_b64_tr_b16 v[154:155], v9 offset:512
  s_waitcnt lgkmcnt(6)
  v_mfma_f32_32x32x16_bf16 v[84:99], v[156:159], v[56:59], v[84:99]
  v_mfma_f32_32x32x16_bf16 v[116:131], v[156:159], v[64:67], v[116:131]
  ds_read_b64_tr_b16 v[156:157], v8 offset:2048
  ds_read_b64_tr_b16 v[158:159], v8 offset:2560
  s_waitcnt lgkmcnt(6)
  v_mfma_f32_32x32x16_bf16 v[100:115], v[160:163], v[56:59], v[100:115]
  v_mfma_f32_32x32x16_bf16 v[132:147], v[160:163], v[64:67], v[132:147]
  ds_read_b64_tr_b16 v[160:161], v9 offset:2048
  ds_read_b64_tr_b16 v[162:163], v9 offset:2560
  s_add_u32 s66, s76, 0xfb0000
  buffer_load_dword v4, v3, s[40:43], s66 offen sc1
  s_waitcnt vmcnt(17)
  s_add_u32 m0, s67, 16384
  s_add_u32 s74, s71, 65536
  buffer_load_dwordx4 v15, s[48:51], s74 offen lds
  s_add_u32 m0, s67, 17408
  s_add_u32 s74, s71, 69632
  buffer_load_dwordx4 v15, s[48:51], s74 offen lds
  s_add_u32 m0, s67, 18432
  s_add_u32 s74, s71, 81920
  buffer_load_dwordx4 v15, s[48:51], s74 offen lds
  s_add_u32 m0, s67, 19456
  s_add_u32 s74, s71, 86016
  buffer_load_dwordx4 v15, s[48:51], s74 offen lds
  s_waitcnt lgkmcnt(6)
  v_mfma_f32_32x32x16_bf16 v[84:99], v[148:151], v[68:71], v[84:99]
  v_mfma_f32_32x32x16_bf16 v[116:131], v[148:151], v[76:79], v[116:131]
  ds_read_b64_tr_b16 v[148:149], v6 offset:32768
  ds_read_b64_tr_b16 v[150:151], v6 offset:33280
  s_waitcnt lgkmcnt(6)
  v_mfma_f32_32x32x16_bf16 v[100:115], v[152:155], v[68:71], v[100:115]
  v_mfma_f32_32x32x16_bf16 v[132:147], v[152:155], v[76:79], v[132:147]
  ds_read_b64_tr_b16 v[152:153], v7 offset:32768
  ds_read_b64_tr_b16 v[154:155], v7 offset:33280
  s_waitcnt lgkmcnt(6)
  v_mfma_f32_32x32x16_bf16 v[84:99], v[156:159], v[72:75], v[84:99]
  v_mfma_f32_32x32x16_bf16 v[116:131], v[156:159], v[80:83], v[116:131]
  ds_read_b64_tr_b16 v[156:157], v6 offset:34816
  ds_read_b64_tr_b16 v[158:159], v6 offset:35328
  s_waitcnt lgkmcnt(6)
  v_mfma_f32_32x32x16_bf16 v[100:115], v[160:163], v[72:75], v[100:115]
  v_mfma_f32_32x32x16_bf16 v[132:147], v[160:163], v[80:83], v[132:147]
  ds_read_b64_tr_b16 v[160:161], v7 offset:34816
  ds_read_b64_tr_b16 v[162:163], v7 offset:35328
  s_waitcnt vmcnt(13)
  s_add_u32 m0, s67, 49152
  s_add_u32 s74, s71, 98304
  buffer_load_dwordx4 v15, s[48:51], s74 offen lds
  s_add_u32 m0, s67, 50176
  s_add_u32 s74, s71, 102400
  buffer_load_dwordx4 v15, s[48:51], s74 offen lds
  s_add_u32 m0, s67, 51200
  s_add_u32 s74, s71, 114688
  buffer_load_dwordx4 v15, s[48:51], s74 offen lds
  s_add_u32 m0, s67, 52224
  s_add_u32 s74, s71, 118784
  buffer_load_dwordx4 v15, s[48:51], s74 offen lds
  s_waitcnt lgkmcnt(6)
  v_mfma_f32_32x32x16_bf16 v[84:99], v[148:151], v[20:23], v[84:99]
  v_mfma_f32_32x32x16_bf16 v[116:131], v[148:151], v[28:31], v[116:131]
  ds_read_b64_tr_b16 v[148:149], v10 offset:16384
  ds_read_b64_tr_b16 v[150:151], v10 offset:16896
  s_waitcnt lgkmcnt(6)
  v_mfma_f32_32x32x16_bf16 v[100:115], v[152:155], v[20:23], v[100:115]
  v_mfma_f32_32x32x16_bf16 v[132:147], v[152:155], v[28:31], v[132:147]
  ds_read_b64_tr_b16 v[152:153], v11 offset:16384
  ds_read_b64_tr_b16 v[154:155], v11 offset:16896
  s_waitcnt lgkmcnt(6)
  v_mfma_f32_32x32x16_bf16 v[84:99], v[156:159], v[24:27], v[84:99]
  v_mfma_f32_32x32x16_bf16 v[116:131], v[156:159], v[32:35], v[116:131]
  ds_read_b64_tr_b16 v[156:157], v10 offset:18432
  ds_read_b64_tr_b16 v[158:159], v10 offset:18944
  s_waitcnt lgkmcnt(6)
  v_mfma_f32_32x32x16_bf16 v[100:115], v[160:163], v[24:27], v[100:115]
  v_mfma_f32_32x32x16_bf16 v[132:147], v[160:163], v[32:35], v[132:147]
  ds_read_b64_tr_b16 v[160:161], v11 offset:18432
  ds_read_b64_tr_b16 v[162:163], v11 offset:18944
  s_waitcnt vmcnt(8)
  v_cmp_ne_u32 vcc, v2, v4
  s_nop 1
  s_cmp_eq_u64 vcc, 0
  s_cbranch_scc1 AOK_16
  s_mov_b32 s63, 0x40000
POLL_17:
  buffer_load_dword v4, v3, s[40:43], s66 offen sc1
  s_waitcnt vmcnt(0) lgkmcnt(0)
  v_cmp_ne_u32 vcc, v2, v4
  s_sub_u32 s63, s63, 1
  s_cmp_eq_u32 s63, 0
  s_cbranch_scc1 POLLED_18
  s_cmp_lg_u64 vcc, 0
  s_cbranch_scc1 POLL_17
POLLED_18:
AOK_16:
  s_add_u32 s74, s73, 0
  buffer_load_dwordx4 v[52:55], v1, s[40:43], s74 offen offset:0 sc1
  buffer_load_dwordx4 v[56:59], v1, s[40:43], s74 offen offset:1024 sc1
  s_add_u32 s74, s73, 32768
  buffer_load_dwordx4 v[60:63], v1, s[40:43], s74 offen offset:0 sc1
  buffer_load_dwordx4 v[64:67], v1, s[40:43], s74 offen offset:1024 sc1
  s_add_u32 s74, s73, 2048
  buffer_load_dwordx4 v[68:71], v1, s[40:43], s74 offen offset:0 sc1
  buffer_load_dwordx4 v[72:75], v1, s[40:43], s74 offen offset:1024 sc1
  s_add_u32 s74, s73, 34816
  buffer_load_dwordx4 v[76:79], v1, s[40:43], s74 offen offset:0 sc1
  buffer_load_dwordx4 v[80:83], v1, s[40:43], s74 offen offset:1024 sc1
  v_and_b32 v19, 31, v0
  v_lshlrev_b32 v19, 7, v19
  v_lshrrev_b32 v13, 5, v0
  v_xor_b32 v13, v13, v5
  v_lshl_add_u32 v19, v13, 4, v19
  v_add_u32 v19, s67, v19
  v_xor_b32 v2, 0, v19
  v_xor_b32 v3, 32, v19
  v_xor_b32 v4, 64, v19
  v_xor_b32 v12, 96, v19
  v_xor_b32 v13, 16, v19
  v_xor_b32 v16, 48, v19
  v_xor_b32 v17, 80, v19
  v_xor_b32 v18, 112, v19
  s_add_u32 s74, s73, 4096
  buffer_load_dwordx4 v[20:23], v1, s[40:43], s74 offen offset:0 sc1
  buffer_load_dwordx4 v[24:27], v1, s[40:43], s74 offen offset:1024 sc1
  s_add_u32 s74, s73, 36864
  buffer_load_dwordx4 v[28:31], v1, s[40:43], s74 offen offset:0 sc1
  buffer_load_dwordx4 v[32:35], v1, s[40:43], s74 offen offset:1024 sc1
  s_waitcnt lgkmcnt(6)
  v_mfma_f32_32x32x16_bf16 v[84:99], v[148:151], v[36:39], v[84:99]
  v_mfma_f32_32x32x16_bf16 v[116:131], v[148:151], v[44:47], v[116:131]
  ds_read_b64_tr_b16 v[148:149], v10 offset:32768
  ds_read_b64_tr_b16 v[150:151], v10 offset:33280
  s_waitcnt lgkmcnt(6)
  v_mfma_f32_32x32x16_bf16 v[100:115], v[152:155], v[36:39], v[100:115]
  v_mfma_f32_32x32x16_bf16 v[132:147], v[152:155], v[44:47], v[132:147]
  ds_read_b64_tr_b16 v[152:153], v11 offset:32768
  ds_read_b64_tr_b16 v[154:155], v11 offset:33280
  s_waitcnt lgkmcnt(6)
  v_mfma_f32_32x32x16_bf16 v[84:99], v[156:159], v[40:43], v[84:99]
  v_mfma_f32_32x32x16_bf16 v[116:131], v[156:159], v[48:51], v[116:131]
  ds_read_b64_tr_b16 v[156:157], v10 offset:34816
  ds_read_b64_tr_b16 v[158:159], v10 offset:35328
  s_waitcnt lgkmcnt(6)
  v_mfma_f32_32x32x16_bf16 v[100:115], v[160:163], v[40:43], v[100:115]
  v_mfma_f32_32x32x16_bf16 v[132:147], v[160:163], v[48:51], v[132:147]
  ds_read_b64_tr_b16 v[160:161], v11 offset:34816
  ds_read_b64_tr_b16 v[162:163], v11 offset:35328
  s_waitcnt vmcnt(8)
  s_add_u32 s74, s73, 6144
  buffer_load_dwordx4 v[36:39], v1, s[40:43], s74 offen offset:0 sc1
  buffer_load_dwordx4 v[40:43], v1, s[40:43], s74 offen offset:1024 sc1
  s_add_u32 s74, s73, 38912
  buffer_load_dwordx4 v[44:47], v1, s[40:43], s74 offen offset:0 sc1
  buffer_load_dwordx4 v[48:51], v1, s[40:43], s74 offen offset:1024 sc1
  s_waitcnt lgkmcnt(6)
  v_mfma_f32_32x32x16_bf16 v[84:99], v[148:151], v[52:55], v[84:99]
  v_mfma_f32_32x32x16_bf16 v[116:131], v[148:151], v[60:63], v[116:131]
  ds_read_b64_tr_b16 v[148:149], v6 offset:0
  ds_read_b64_tr_b16 v[150:151], v6 offset:512
  s_waitcnt lgkmcnt(6)
  v_mfma_f32_32x32x16_bf16 v[100:115], v[152:155], v[52:55], v[100:115]
  v_mfma_f32_32x32x16_bf16 v[132:147], v[152:155], v[60:63], v[132:147]
  ds_read_b64_tr_b16 v[152:153], v7 offset:0
  ds_read_b64_tr_b16 v[154:155], v7 offset:512
  s_waitcnt lgkmcnt(6)
  v_mfma_f32_32x32x16_bf16 v[84:99], v[156:159], v[56:59], v[84:99]
  v_mfma_f32_32x32x16_bf16 v[116:131], v[156:159], v[64:67], v[116:131]
  ds_read_b64_tr_b16 v[156:157], v6 offset:2048
  ds_read_b64_tr_b16 v[158:159], v6 offset:2560
  s_waitcnt lgkmcnt(6)
  v_mfma_f32_32x32x16_bf16 v[100:115], v[160:163], v[56:59], v[100:115]
  v_mfma_f32_32x32x16_bf16 v[132:147], v[160:163], v[64:67], v[132:147]
  ds_read_b64_tr_b16 v[160:161], v7 offset:2048
  ds_read_b64_tr_b16 v[162:163], v7 offset:2560
  s_waitcnt vmcnt(8)
  s_waitcnt lgkmcnt(6)
  v_mfma_f32_32x32x16_bf16 v[84:99], v[148:151], v[68:71], v[84:99]
  v_mfma_f32_32x32x16_bf16 v[116:131], v[148:151], v[76:79], v[116:131]
  ds_read_b64_tr_b16 v[148:149], v6 offset:16384
  ds_read_b64_tr_b16 v[150:151], v6 offset:16896
  s_waitcnt lgkmcnt(6)
  v_mfma_f32_32x32x16_bf16 v[100:115], v[152:155], v[68:71], v[100:115]
  v_mfma_f32_32x32x16_bf16 v[132:147], v[152:155], v[76:79], v[132:147]
  ds_read_b64_tr_b16 v[152:153], v7 offset:16384
  ds_read_b64_tr_b16 v[154:155], v7 offset:16896
  s_waitcnt lgkmcnt(6)
  v_mfma_f32_32x32x16_bf16 v[84:99], v[156:159], v[72:75], v[84:99]
  v_mfma_f32_32x32x16_bf16 v[116:131], v[156:159], v[80:83], v[116:131]
  ds_read_b64_tr_b16 v[156:157], v6 offset:18432
  ds_read_b64_tr_b16 v[158:159], v6 offset:18944
  s_waitcnt lgkmcnt(6)
  v_mfma_f32_32x32x16_bf16 v[100:115], v[160:163], v[72:75], v[100:115]
  v_mfma_f32_32x32x16_bf16 v[132:147], v[160:163], v[80:83], v[132:147]
  ds_read_b64_tr_b16 v[160:161], v7 offset:18432
  ds_read_b64_tr_b16 v[162:163], v7 offset:18944
  s_waitcnt vmcnt(4)
  s_waitcnt lgkmcnt(6)
  v_mfma_f32_32x32x16_bf16 v[84:99], v[148:151], v[20:23], v[84:99]
  v_mfma_f32_32x32x16_bf16 v[116:131], v[148:151], v[28:31], v[116:131]
  ds_read_b64_tr_b16 v[148:149], v8 offset:0
  ds_read_b64_tr_b16 v[150:151], v8 offset:512
  s_waitcnt lgkmcnt(6)
  v_mfma_f32_32x32x16_bf16 v[100:115], v[152:155], v[20:23], v[100:115]
  v_mfma_f32_32x32x16_bf16 v[132:147], v[152:155], v[28:31], v[132:147]
  ds_read_b64_tr_b16 v[152:153], v9 offset:0
  ds_read_b64_tr_b16 v[154:155], v9 offset:512
  s_waitcnt lgkmcnt(6)
  v_mfma_f32_32x32x16_bf16 v[84:99], v[156:159], v[24:27], v[84:99]
  v_mfma_f32_32x32x16_bf16 v[116:131], v[156:159], v[32:35], v[116:131]
  ds_read_b64_tr_b16 v[156:157], v8 offset:2048
  ds_read_b64_tr_b16 v[158:159], v8 offset:2560
  s_waitcnt lgkmcnt(6)
  v_mfma_f32_32x32x16_bf16 v[100:115], v[160:163], v[24:27], v[100:115]
  v_mfma_f32_32x32x16_bf16 v[132:147], v[160:163], v[32:35], v[132:147]
  ds_read_b64_tr_b16 v[160:161], v9 offset:2048
  ds_read_b64_tr_b16 v[162:163], v9 offset:2560
  s_waitcnt vmcnt(0)
  s_waitcnt lgkmcnt(0)
  v_mfma_f32_32x32x16_bf16 v[84:99], v[148:151], v[36:39], v[84:99]
  v_mfma_f32_32x32x16_bf16 v[84:99], v[156:159], v[40:43], v[84:99]
  v_mfma_f32_32x32x16_bf16 v[100:115], v[152:155], v[36:39], v[100:115]
  v_mfma_f32_32x32x16_bf16 v[100:115], v[160:163], v[40:43], v[100:115]
  v_mfma_f32_32x32x16_bf16 v[116:131], v[148:151], v[44:47], v[116:131]
  v_mfma_f32_32x32x16_bf16 v[116:131], v[156:159], v[48:51], v[116:131]
  s_nop 7
  ds_write_b128 v2, v[84:87] offset:0
  ds_write_b128 v3, v[88:91] offset:0
  ds_write_b128 v4, v[92:95] offset:0
  ds_write_b128 v12, v[96:99] offset:0
  v_mfma_f32_32x32x16_bf16 v[132:147], v[152:155], v[44:47], v[132:147]
  v_mfma_f32_32x32x16_bf16 v[132:147], v[160:163], v[48:51], v[132:147]
  ds_write_b128 v13, v[100:103] offset:16384
  ds_write_b128 v16, v[104:107] offset:16384
  ds_write_b128 v17, v[108:111] offset:16384
  ds_write_b128 v18, v[112:115] offset:16384
  ds_write_b128 v2, v[116:119] offset:32768
  ds_write_b128 v3, v[120:123] offset:32768
  ds_write_b128 v4, v[124:127] offset:32768
  ds_write_b128 v12, v[128:131] offset:32768
  s_nop 3
  ds_write_b128 v13, v[132:135] offset:49152
  ds_write_b128 v16, v[136:139] offset:49152
  ds_write_b128 v17, v[140:143] offset:49152
  ds_write_b128 v18, v[144:147] offset:49152
  s_waitcnt lgkmcnt(0)
  s_barrier
  s_endpgm
.p2align 7
L_UTIL:
  s_setprio 3
  v_and_b32 v5, 7, v0
  s_and_b32 s23, s2, 3
  s_lshl_b32 s23, s23, 2
  s_bfe_u32 s3, s2, 0x20003
  s_add_u32 s23, s23, s3
  s_and_b32 s19, s18, 3
  s_xor_b32 s22, s23, 1
  v_mov_b32 v80, 0
  v_lshrrev_b32 v4, 5, v0
  v_and_b32 v6, 31, v0
  v_lshlrev_b32 v6, 4, v6
  v_lshl_add_u32 v6, v4, 10, v6
  v_lshlrev_b32 v81, 4, v4
  s_lshl_b32 s64, s20, 7
  s_lshl_b32 s65, s23, 3
  s_add_u32 s64, s64, s65
  s_lshl_b32 s65, s19, 1
  s_add_u32 s64, s64, s65
  s_lshl_b32 s65, s64, 10
  s_mov_b32 s3, 0xf80000
  s_waitcnt lgkmcnt(0)
  s_mov_b32 s40, s16
  s_and_b32 s41, s17, 0xffff
  s_mov_b32 s42, 0x1000000
  s_mov_b32 s43, 0x20000
  buffer_load_dword v80, v80, s[40:43], s3 offen sc1
  s_mov_b32 s36, s4
  s_and_b32 s37, s5, 0xffff
  s_mov_b32 s38, 0x200000
  s_mov_b32 s39, 0x20000
  buffer_load_dwordx4 v[16:19], v6, s[36:39], s65 offen
  buffer_load_dwordx4 v[20:23], v6, s[36:39], s65 offen offset:512
  s_mov_b32 s28, s6
  s_and_b32 s29, s7, 0xffff
  s_mov_b32 s30, 0x180000
  s_mov_b32 s31, 0x20000
  s_mov_b32 s32, s12
  s_and_b32 s33, s13, 0xffff
  s_mov_b32 s34, 0x1c0000
  s_mov_b32 s35, 0x20000
  s_add_u32 s66, s23, 8
  s_add_u32 s67, s22, 24
  s_cmp_eq_u32 s19, 1
  s_cselect_b32 s66, s67, s66
  s_add_u32 s67, s23, 32
  s_cmp_lt_u32 s23, 8
  s_cselect_b32 s67, s23, s67
  s_cmp_eq_u32 s19, 2
  s_cselect_b32 s66, s67, s66
  s_add_u32 s67, s23, 48
  s_cmp_eq_u32 s19, 3
  s_cselect_b32 s66, s67, s66
  v_lshrrev_b32 v2, 3, v0
  v_lshlrev_b32 v3, 4, v5
  s_cmp_ge_u32 s66, 52
  s_cbranch_scc1 CSD_34
  s_lshl_b32 s67, s66, 7
  s_cmp_ge_u32 s66, 24
  s_cbranch_scc1 CSW_33
  v_mul_u32_u24 v4, 3072, v2
  v_add_u32 v4, v4, v3
  s_mul_i32 s68, s20, 98304
  s_add_u32 s68, s68, s67
  buffer_load_dwordx4 v[48:51], v4, s[28:31], s68 offen
  s_add_u32 s68, s68, 24576
  buffer_load_dwordx4 v[52:55], v4, s[28:31], s68 offen
  s_add_u32 s68, s68, 24576
  buffer_load_dwordx4 v[56:59], v4, s[28:31], s68 offen
  s_add_u32 s68, s68, 24576
  buffer_load_dwordx4 v[60:63], v4, s[28:31], s68 offen
  s_branch CSD_34
CSW_33:
  v_mul_u32_u24 v4, 3584, v2
  v_add_u32 v4, v4, v3
  s_mul_i32 s68, s20, 114688
  s_add_u32 s68, s68, s67
  s_sub_u32 s68, s68, 3072
  buffer_load_dwordx4 v[48:51], v4, s[32:35], s68 offen
  s_add_u32 s68, s68, 28672
  buffer_load_dwordx4 v[52:55], v4, s[32:35], s68 offen
  s_add_u32 s68, s68, 28672
  buffer_load_dwordx4 v[56:59], v4, s[32:35], s68 offen
  s_add_u32 s68, s68, 28672
  buffer_load_dwordx4 v[60:63], v4, s[32:35], s68 offen
CSD_34:
  s_and_b32 s72, s23, 7
  s_cmp_lg_u32 s72, 3
  s_cbranch_scc1 NOP4_35
  s_cmp_lg_u32 s19, 1
  s_cbranch_scc1 NOP4_35
  s_and_b32 s72, s20, 7
  v_lshlrev_b32 v2, 3, v0
  v_add_u32 v2, s72, v2
  v_mul_u32_u24 v2, 3072, v2
  s_lshl_b32 s72, s23, 7
  buffer_load_dword v162, v2, s[28:31], s72 offen offset:1024
NOP4_35:
  s_lshl_b32 s24, s20, 4
  s_add_u32 s24, s24, s23
  s_lshl_b32 s24, s24, 7
  s_lshl_b32 s58, s20, 1
  s_lshr_b32 s59, s23, 3
  s_add_u32 s58, s58, s59
  s_and_b32 s59, s23, 7
  s_xor_b32 s59, s59, 2
  s_mov_b32 s69, 0xffff0000
  s_mov_b32 s70, 0x3b000000
  s_lshl_b32 s64, s64, 4
  s_add_u32 s64, s64, 0xf00000
  v_lshlrev_b32 v14, 4, v0
  s_lshl_b32 s71, s23, 8
  s_add_u32 s72, s71, 2048
  v_add_u32 v15, s72, v14
  s_lshl_b32 s72, s22, 8
  s_add_u32 s72, s72, 5888
  v_add_u32 v2, s72, v14
  v_cmp_le_u32 vcc, 16, v0
  s_lshl_b32 s72, s23, 7
  s_sub_u32 s72, s72, 512
  v_cndmask_b32 v15, v15, v2, vcc
  v_add_u32 v2, s72, v14
  v_cmp_le_u32 vcc, 32, v0
  s_mul_i32 s72, s23, 192
  s_add_u32 s72, s72, 9600
  v_cndmask_b32 v15, v15, v2, vcc
  v_min_u32 v2, 51, v0
  v_lshlrev_b32 v2, 4, v2
  v_add_u32 v2, s72, v2
  v_cmp_le_u32 vcc, 40, v0
  s_nop 1
  v_cndmask_b32 v15, v15, v2, vcc
  s_barrier
  s_cmp_ge_u32 s66, 52
  s_cbranch_scc1 L_P0A
  s_waitcnt vmcnt(4)
  s_branch L_P0B
L_P0A:
  s_waitcnt vmcnt(0)
L_P0B:
  v_lshlrev_b32 v24, 16, v16
  v_and_b32 v25, s69, v16
  v_lshlrev_b32 v26, 16, v17
  v_and_b32 v27, s69, v17
  v_lshlrev_b32 v28, 16, v18
  v_and_b32 v29, s69, v18
  v_lshlrev_b32 v30, 16, v19
  v_and_b32 v31, s69, v19
  v_lshlrev_b32 v32, 16, v20
  v_and_b32 v33, s69, v20
  v_lshlrev_b32 v34, 16, v21
  v_and_b32 v35, s69, v21
  v_lshlrev_b32 v36, 16, v22
  v_and_b32 v37, s69, v22
  v_lshlrev_b32 v38, 16, v23
  v_and_b32 v39, s69, v23
  v_add_f32 v40, v24, v28
  v_add_f32 v41, v25, v29
  v_add_f32 v42, v26, v30
  v_add_f32 v43, v27, v31
  v_add_f32 v40, v40, v32
  v_add_f32 v41, v41, v33
  v_add_f32 v42, v42, v34
  v_add_f32 v43, v43, v35
  v_add_f32 v40, v40, v36
  v_add_f32 v41, v41, v37
  v_add_f32 v42, v42, v38
  v_add_f32 v43, v43, v39
  v_add_f32 v40, v40, v41
  v_add_f32 v42, v42, v43
  v_add_f32 v40, v40, v42
  s_nop 1
  v_add_f32_dpp v40, v40, v40 quad_perm:[1,0,3,2] row_mask:0xf bank_mask:0xf
  s_nop 1
  v_add_f32_dpp v40, v40, v40 quad_perm:[2,3,0,1] row_mask:0xf bank_mask:0xf
  s_nop 1
  v_add_f32_dpp v40, v40, v40 row_half_mirror row_mask:0xf bank_mask:0xf
  s_nop 1
  v_add_f32_dpp v40, v40, v40 row_mirror row_mask:0xf bank_mask:0xf
  v_mov_b32 v41, v40
  s_nop 1
  v_permlane16_swap_b32 v40, v41
  s_nop 1
  v_add_f32 v40, v40, v41
  v_mul_f32 v40, s70, v40
  v_add_u32 v46, 0x9e3779b9, v80
  v_mov_b32 v2, 161792
  v_mov_b32 v3, 0
  ds_write_b32 v2, v46
  v_lshl_add_u32 v2, v0, 2, v2
  s_mov_b64 exec, -2
  ds_write_b32 v2, v3
  s_mov_b64 exec, -1
  s_barrier
  v_sub_f32 v24, v24, v40
  v_sub_f32 v25, v25, v40
  v_sub_f32 v26, v26, v40
  v_sub_f32 v27, v27, v40
  v_sub_f32 v28, v28, v40
  v_sub_f32 v29, v29, v40
  v_sub_f32 v30, v30, v40
  v_sub_f32 v31, v31, v40
  v_sub_f32 v32, v32, v40
  v_sub_f32 v33, v33, v40
  v_sub_f32 v34, v34, v40
  v_sub_f32 v35, v35, v40
  v_sub_f32 v36, v36, v40
  v_sub_f32 v37, v37, v40
  v_sub_f32 v38, v38, v40
  v_sub_f32 v39, v39, v40
  v_mul_f32 v16, v24, v24
  v_mul_f32 v17, v25, v25
  v_mul_f32 v18, v26, v26
  v_mul_f32 v19, v27, v27
  v_fmac_f32 v16, v28, v28
  v_fmac_f32 v17, v29, v29
  v_fmac_f32 v18, v30, v30
  v_fmac_f32 v19, v31, v31
  v_fmac_f32 v16, v32, v32
  v_fmac_f32 v17, v33, v33
  v_fmac_f32 v18, v34, v34
  v_fmac_f32 v19, v35, v35
  v_fmac_f32 v16, v36, v36
  v_fmac_f32 v17, v37, v37
  v_fmac_f32 v18, v38, v38
  v_fmac_f32 v19, v39, v39
  v_add_f32 v16, v16, v17
  v_add_f32 v18, v18, v19
  v_add_f32 v44, v16, v18
  s_nop 1
  v_add_f32_dpp v44, v44, v44 quad_perm:[1,0,3,2] row_mask:0xf bank_mask:0xf
  s_nop 1
  v_add_f32_dpp v44, v44, v44 quad_perm:[2,3,0,1] row_mask:0xf bank_mask:0xf
  s_nop 1
  v_add_f32_dpp v44, v44, v44 row_half_mirror row_mask:0xf bank_mask:0xf
  s_nop 1
  v_add_f32_dpp v44, v44, v44 row_mirror row_mask:0xf bank_mask:0xf
  v_mov_b32 v45, v44
  s_nop 1
  v_permlane16_swap_b32 v44, v45
  s_nop 1
  v_add_f32 v44, v44, v45
  v_mov_b32 v45, 0x3727c5ac
  v_fma_f32 v44, v44, s70, v45
  v_rsq_f32 v44, v44
  v_readfirstlane_b32 s61, v46
  v_mov_b32 v47, v46
  v_mul_f32 v45, v40, v44
  v_sub_f32 v45, 0, v45
  s_mov_b32 s71, 0xff
  v_bfi_b32 v44, s71, v46, v44
  v_bfi_b32 v45, s71, v46, v45
  s_mov_b32 exec_lo, 1
  s_mov_b32 exec_hi, 1
  buffer_store_dwordx4 v[44:47], v81, s[40:43], s64 offen sc1
  s_mov_b64 exec, -1
  s_waitcnt vmcnt(1)
  v_lshlrev_b32 v64, 16, v48
  v_and_b32 v65, s69, v48
  v_lshlrev_b32 v66, 16, v49
  v_and_b32 v67, s69, v49
  v_lshlrev_b32 v68, 16, v50
  v_and_b32 v69, s69, v50
  v_lshlrev_b32 v70, 16, v51
  v_and_b32 v71, s69, v51
  v_lshlrev_b32 v72, 16, v52
  v_and_b32 v73, s69, v52
  v_lshlrev_b32 v74, 16, v53
  v_and_b32 v75, s69, v53
  v_lshlrev_b32 v76, 16, v54
  v_and_b32 v77, s69, v54
  v_lshlrev_b32 v78, 16, v55
  v_and_b32 v79, s69, v55
  v_add_f32 v64, v64, v72
  v_add_f32 v65, v65, v73
  v_add_f32 v66, v66, v74
  v_add_f32 v67, v67, v75
  v_add_f32 v68, v68, v76
  v_add_f32 v69, v69, v77
  v_add_f32 v70, v70, v78
  v_add_f32 v71, v71, v79
  v_lshlrev_b32 v72, 16, v56
  v_and_b32 v73, s69, v56
  v_lshlrev_b32 v74, 16, v57
  v_and_b32 v75, s69, v57
  v_lshlrev_b32 v76, 16, v58
  v_and_b32 v77, s69, v58
  v_lshlrev_b32 v78, 16, v59
  v_and_b32 v79, s69, v59
  v_add_f32 v64, v64, v72
  v_add_f32 v65, v65, v73
  v_add_f32 v66, v66, v74
  v_add_f32 v67, v67, v75
  v_add_f32 v68, v68, v76
  v_add_f32 v69, v69, v77
  v_add_f32 v70, v70, v78
  v_add_f32 v71, v71, v79
  v_lshlrev_b32 v72, 16, v60
  v_and_b32 v73, s69, v60
  v_lshlrev_b32 v74, 16, v61
  v_and_b32 v75, s69, v61
  v_lshlrev_b32 v76, 16, v62
  v_and_b32 v77, s69, v62
  v_lshlrev_b32 v78, 16, v63
  v_and_b32 v79, s69, v63
  v_add_f32 v64, v64, v72
  v_add_f32 v65, v65, v73
  v_add_f32 v66, v66, v74
  v_add_f32 v67, v67, v75
  v_add_f32 v68, v68, v76
  v_add_f32 v69, v69, v77
  v_add_f32 v70, v70, v78
  v_add_f32 v71, v71, v79
  s_nop 1
  v_add_f32_dpp v64, v64, v64 row_ror:8 row_mask:0xf bank_mask:0xf
  v_add_f32_dpp v65, v65, v65 row_ror:8 row_mask:0xf bank_mask:0xf
  v_add_f32_dpp v66, v66, v66 row_ror:8 row_mask:0xf bank_mask:0xf
  v_add_f32_dpp v67, v67, v67 row_ror:8 row_mask:0xf bank_mask:0xf
  v_add_f32_dpp v68, v68, v68 row_ror:8 row_mask:0xf bank_mask:0xf
  v_add_f32_dpp v69, v69, v69 row_ror:8 row_mask:0xf bank_mask:0xf
  v_add_f32_dpp v70, v70, v70 row_ror:8 row_mask:0xf bank_mask:0xf
  v_add_f32_dpp v71, v71, v71 row_ror:8 row_mask:0xf bank_mask:0xf
  s_mov_b32 s72, 0xff00ff00
  s_mov_b32 s73, 0xff00ff00
  v_cndmask_b32 v64, v64, v68, s[72:73]
  v_cndmask_b32 v65, v65, v69, s[72:73]
  v_cndmask_b32 v66, v66, v70, s[72:73]
  v_cndmask_b32 v67, v67, v71, s[72:73]
  v_mov_b32 v72, v64
  v_mov_b32 v73, v65
  v_mov_b32 v74, v66
  v_mov_b32 v75, v67
  s_nop 0
  v_permlane16_swap_b32 v64, v72
  v_permlane16_swap_b32 v65, v73
  v_permlane16_swap_b32 v66, v74
  v_permlane16_swap_b32 v67, v75
  v_add_f32 v64, v64, v72
  v_add_f32 v65, v65, v73
  v_add_f32 v66, v66, v74
  v_add_f32 v67, v67, v75
  v_mov_b32 v72, v64
  v_mov_b32 v73, v65
  v_mov_b32 v74, v66
  v_mov_b32 v75, v67
  s_nop 0
  v_permlane32_swap_b32 v64, v72
  v_permlane32_swap_b32 v65, v73
  v_permlane32_swap_b32 v66, v74
  v_permlane32_swap_b32 v67, v75
  v_add_f32 v64, v64, v72
  v_add_f32 v65, v65, v73
  v_add_f32 v66, v66, v74
  v_add_f32 v67, v67, v75
  s_mov_b32 s71, 0xff
  v_bfe_u32 v74, v0, 3, 1
  v_bfi_b32 v64, s71, v46, v64
  v_bfi_b32 v65, s71, v46, v65
  v_bfi_b32 v66, s71, v46, v66
  v_bfi_b32 v67, s71, v46, v67
  v_lshlrev_b32 v73, 5, v5
  v_lshl_add_u32 v73, v74, 4, v73
  s_mul_i32 s71, s20, 13312
  s_lshl_b32 s72, s66, 8
  s_add_u32 s71, s71, s72
  s_add_u32 s71, s71, 0xf10000
  s_cmp_ge_u32 s66, 52
  s_cbranch_scc1 P2S_36
  s_mov_b64 exec, 0xffff
  buffer_store_dwordx4 v[64:67], v73, s[40:43], s71 offen sc1
  s_mov_b64 exec, -1
P2S_36:
  s_waitcnt lgkmcnt(0)
  s_barrier
  s_cmp_lg_u32 s19, 1
  s_cbranch_scc1 NOPF_37
  s_mov_b32 s44, s14
  s_and_b32 s45, s15, 0xffff
  s_mov_b32 s46, 0x1c0000
  s_mov_b32 s47, 0x20000
  s_mov_b32 s48, s8
  s_and_b32 s49, s9, 0xffff
  s_mov_b32 s50, 0x80000
  s_mov_b32 s51, 0x20000
  v_lshlrev_b32 v2, 7, v0
  s_mul_i32 s71, s2, 7168
  s_mov_b32 exec_hi, 0xffffff
  buffer_load_dword v160, v2, s[44:47], s71 offen
  s_lshl_b32 s71, s2, 11
  s_mov_b64 exec, 0xffff
  buffer_load_dword v161, v2, s[48:51], s71 offen
  s_mov_b64 exec, -1
NOPF_37:
  s_barrier
  s_cmp_lg_u32 s19, 2
  s_cbranch_scc1 NOP3_38
  s_bitcmp1_b32 s59, 2
  s_cbranch_scc1 NOP3_38
  s_mov_b32 s44, s14
  s_and_b32 s45, s15, 0xffff
  s_mov_b32 s46, 0x1c0000
  s_mov_b32 s47, 0x20000
  s_mov_b32 s48, s8
  s_and_b32 s49, s9, 0xffff
  s_mov_b32 s50, 0x80000
  s_mov_b32 s51, 0x20000
  v_lshlrev_b32 v2, 10, v0
  s_lshr_b32 s72, s2, 3
  s_mul_i32 s71, s72, 57344
  s_mov_b32 exec_hi, 0xffffff
  buffer_load_dword v160, v2, s[44:47], s71 offen offset:384
  s_lshl_b32 s71, s72, 14
  s_mov_b64 exec, 0xffff
  buffer_load_dword v161, v2, s[48:51], s71 offen offset:384
  s_mov_b64 exec, -1
NOP3_38:
  s_barrier
  s_cmp_lg_u32 s19, 0
  s_cbranch_scc1 NOPOST_39
  s_mov_b32 s71, 0xf10000
  buffer_load_dwordx4 v[84:87], v15, s[40:43], s71 offen sc1
  s_add_u32 s71, s71, 13312
  buffer_load_dwordx4 v[88:91], v15, s[40:43], s71 offen sc1
  s_add_u32 s71, s71, 13312
  buffer_load_dwordx4 v[92:95], v15, s[40:43], s71 offen sc1
  s_add_u32 s71, s71, 13312
  buffer_load_dwordx4 v[96:99], v15, s[40:43], s71 offen sc1
  s_add_u32 s71, s71, 13312
  buffer_load_dwordx4 v[100:103], v15, s[40:43], s71 offen sc1
  s_add_u32 s71, s71, 13312
  buffer_load_dwordx4 v[104:107], v15, s[40:43], s71 offen sc1
  s_add_u32 s71, s71, 13312
  buffer_load_dwordx4 v[108:111], v15, s[40:43], s71 offen sc1
  s_add_u32 s71, s71, 13312
  buffer_load_dwordx4 v[112:115], v15, s[40:43], s71 offen sc1
  s_add_u32 s71, s71, 13312
  buffer_load_dwordx4 v[116:119], v15, s[40:43], s71 offen sc1
  s_add_u32 s71, s71, 13312
  buffer_load_dwordx4 v[120:123], v15, s[40:43], s71 offen sc1
  s_add_u32 s71, s71, 13312
  buffer_load_dwordx4 v[124:127], v15, s[40:43], s71 offen sc1
  s_add_u32 s71, s71, 13312
  buffer_load_dwordx4 v[128:131], v15, s[40:43], s71 offen sc1
  s_add_u32 s71, s71, 13312
  buffer_load_dwordx4 v[132:135], v15, s[40:43], s71 offen sc1
  s_add_u32 s71, s71, 13312
  buffer_load_dwordx4 v[136:139], v15, s[40:43], s71 offen sc1
  s_add_u32 s71, s71, 13312
  buffer_load_dwordx4 v[140:143], v15, s[40:43], s71 offen sc1
  s_add_u32 s71, s71, 13312
  buffer_load_dwordx4 v[144:147], v15, s[40:43], s71 offen sc1
  s_add_u32 s71, s71, 13312
  s_lshl_b32 s71, s20, 11
  s_add_u32 s71, s71, 0xf00000
  buffer_load_dwordx4 v[148:151], v14, s[40:43], s71 offen offset:0 sc1
  buffer_load_dwordx4 v[152:155], v14, s[40:43], s71 offen offset:1024 sc1
NOPOST_39:
  s_barrier
  s_barrier
  s_cmp_lg_u32 s19, 0
  s_cbranch_scc1 NOPOST_40
  s_mov_b32 s73, 0x20000
L_CHK:
  s_waitcnt vmcnt(0)
  v_xor_b32 v2, s61, v84
  v_bitop3_b32 v2, v2, v85, s61 bitop3:0xf6
  v_bitop3_b32 v2, v2, v86, s61 bitop3:0xf6
  v_bitop3_b32 v2, v2, v87, s61 bitop3:0xf6
  v_bitop3_b32 v2, v2, v88, s61 bitop3:0xf6
  v_bitop3_b32 v2, v2, v89, s61 bitop3:0xf6
  v_bitop3_b32 v2, v2, v90, s61 bitop3:0xf6
  v_bitop3_b32 v2, v2, v91, s61 bitop3:0xf6
  v_bitop3_b32 v2, v2, v92, s61 bitop3:0xf6
  v_bitop3_b32 v2, v2, v93, s61 bitop3:0xf6
  v_bitop3_b32 v2, v2, v94, s61 bitop3:0xf6
  v_bitop3_b32 v2, v2, v95, s61 bitop3:0xf6
  v_bitop3_b32 v2, v2, v96, s61 bitop3:0xf6
  v_bitop3_b32 v2, v2, v97, s61 bitop3:0xf6
  v_bitop3_b32 v2, v2, v98, s61 bitop3:0xf6
  v_bitop3_b32 v2, v2, v99, s61 bitop3:0xf6
  v_bitop3_b32 v2, v2, v100, s61 bitop3:0xf6
  v_bitop3_b32 v2, v2, v101, s61 bitop3:0xf6
  v_bitop3_b32 v2, v2, v102, s61 bitop3:0xf6
  v_bitop3_b32 v2, v2, v103, s61 bitop3:0xf6
  v_bitop3_b32 v2, v2, v104, s61 bitop3:0xf6
  v_bitop3_b32 v2, v2, v105, s61 bitop3:0xf6
  v_bitop3_b32 v2, v2, v106, s61 bitop3:0xf6
  v_bitop3_b32 v2, v2, v107, s61 bitop3:0xf6
  v_bitop3_b32 v2, v2, v108, s61 bitop3:0xf6
  v_bitop3_b32 v2, v2, v109, s61 bitop3:0xf6
  v_bitop3_b32 v2, v2, v110, s61 bitop3:0xf6
  v_bitop3_b32 v2, v2, v111, s61 bitop3:0xf6
  v_bitop3_b32 v2, v2, v112, s61 bitop3:0xf6
  v_bitop3_b32 v2, v2, v113, s61 bitop3:0xf6
  v_bitop3_b32 v2, v2, v114, s61 bitop3:0xf6
  v_bitop3_b32 v2, v2, v115, s61 bitop3:0xf6
  v_bitop3_b32 v2, v2, v116, s61 bitop3:0xf6
  v_bitop3_b32 v2, v2, v117, s61 bitop3:0xf6
  v_bitop3_b32 v2, v2, v118, s61 bitop3:0xf6
  v_bitop3_b32 v2, v2, v119, s61 bitop3:0xf6
  v_bitop3_b32 v2, v2, v120, s61 bitop3:0xf6
  v_bitop3_b32 v2, v2, v121, s61 bitop3:0xf6
  v_bitop3_b32 v2, v2, v122, s61 bitop3:0xf6
  v_bitop3_b32 v2, v2, v123, s61 bitop3:0xf6
  v_bitop3_b32 v2, v2, v124, s61 bitop3:0xf6
  v_bitop3_b32 v2, v2, v125, s61 bitop3:0xf6
  v_bitop3_b32 v2, v2, v126, s61 bitop3:0xf6
  v_bitop3_b32 v2, v2, v127, s61 bitop3:0xf6
  v_bitop3_b32 v2, v2, v128, s61 bitop3:0xf6
  v_bitop3_b32 v2, v2, v129, s61 bitop3:0xf6
  v_bitop3_b32 v2, v2, v130, s61 bitop3:0xf6
  v_bitop3_b32 v2, v2, v131, s61 bitop3:0xf6
  v_bitop3_b32 v2, v2, v132, s61 bitop3:0xf6
  v_bitop3_b32 v2, v2, v133, s61 bitop3:0xf6
  v_bitop3_b32 v2, v2, v134, s61 bitop3:0xf6
  v_bitop3_b32 v2, v2, v135, s61 bitop3:0xf6
  v_bitop3_b32 v2, v2, v136, s61 bitop3:0xf6
  v_bitop3_b32 v2, v2, v137, s61 bitop3:0xf6
  v_bitop3_b32 v2, v2, v138, s61 bitop3:0xf6
  v_bitop3_b32 v2, v2, v139, s61 bitop3:0xf6
  v_bitop3_b32 v2, v2, v140, s61 bitop3:0xf6
  v_bitop3_b32 v2, v2, v141, s61 bitop3:0xf6
  v_bitop3_b32 v2, v2, v142, s61 bitop3:0xf6
  v_bitop3_b32 v2, v2, v143, s61 bitop3:0xf6
  v_bitop3_b32 v2, v2, v144, s61 bitop3:0xf6
  v_bitop3_b32 v2, v2, v145, s61 bitop3:0xf6
  v_bitop3_b32 v2, v2, v146, s61 bitop3:0xf6
  v_bitop3_b32 v2, v2, v147, s61 bitop3:0xf6
  v_bitop3_b32 v2, v2, v148, s61 bitop3:0xf6
  v_bitop3_b32 v2, v2, v149, s61 bitop3:0xf6
  v_bitop3_b32 v2, v2, v152, s61 bitop3:0xf6
  v_bitop3_b32 v2, v2, v153, s61 bitop3:0xf6
  v_and_b32 v2, 0xff, v2
  v_bitop3_b32 v2, v2, v150, s61 bitop3:0xf6
  v_bitop3_b32 v2, v2, v151, s61 bitop3:0xf6
  v_bitop3_b32 v2, v2, v154, s61 bitop3:0xf6
  v_bitop3_b32 v2, v2, v155, s61 bitop3:0xf6
  v_cmp_ne_u32 vcc, 0, v2
  s_sub_u32 s73, s73, 1
  s_cmp_eq_u32 s73, 0
  s_cbranch_scc1 L_GOT
  s_cmp_eq_u64 vcc, 0
  s_cbranch_scc1 L_GOT
  s_mov_b32 s71, 0xf10000
  buffer_load_dwordx4 v[84:87], v15, s[40:43], s71 offen sc1
  s_add_u32 s71, s71, 13312
  buffer_load_dwordx4 v[88:91], v15, s[40:43], s71 offen sc1
  s_add_u32 s71, s71, 13312
  buffer_load_dwordx4 v[92:95], v15, s[40:43], s71 offen sc1
  s_add_u32 s71, s71, 13312
  buffer_load_dwordx4 v[96:99], v15, s[40:43], s71 offen sc1
  s_add_u32 s71, s71, 13312
  buffer_load_dwordx4 v[100:103], v15, s[40:43], s71 offen sc1
  s_add_u32 s71, s71, 13312
  buffer_load_dwordx4 v[104:107], v15, s[40:43], s71 offen sc1
  s_add_u32 s71, s71, 13312
  buffer_load_dwordx4 v[108:111], v15, s[40:43], s71 offen sc1
  s_add_u32 s71, s71, 13312
  buffer_load_dwordx4 v[112:115], v15, s[40:43], s71 offen sc1
  s_add_u32 s71, s71, 13312
  buffer_load_dwordx4 v[116:119], v15, s[40:43], s71 offen sc1
  s_add_u32 s71, s71, 13312
  buffer_load_dwordx4 v[120:123], v15, s[40:43], s71 offen sc1
  s_add_u32 s71, s71, 13312
  buffer_load_dwordx4 v[124:127], v15, s[40:43], s71 offen sc1
  s_add_u32 s71, s71, 13312
  buffer_load_dwordx4 v[128:131], v15, s[40:43], s71 offen sc1
  s_add_u32 s71, s71, 13312
  buffer_load_dwordx4 v[132:135], v15, s[40:43], s71 offen sc1
  s_add_u32 s71, s71, 13312
  buffer_load_dwordx4 v[136:139], v15, s[40:43], s71 offen sc1
  s_add_u32 s71, s71, 13312
  buffer_load_dwordx4 v[140:143], v15, s[40:43], s71 offen sc1
  s_add_u32 s71, s71, 13312
  buffer_load_dwordx4 v[144:147], v15, s[40:43], s71 offen sc1
  s_add_u32 s71, s71, 13312
  s_lshl_b32 s71, s20, 11
  s_add_u32 s71, s71, 0xf00000
  buffer_load_dwordx4 v[148:151], v14, s[40:43], s71 offen offset:0 sc1
  buffer_load_dwordx4 v[152:155], v14, s[40:43], s71 offen offset:1024 sc1
  s_branch L_CHK
L_GOT:
NOPOST_40:
  s_barrier
  s_cmp_lg_u32 s19, 0
  s_cbranch_scc1 NOPOST_41
  s_mov_b32 s71, 0xffffff00
  v_and_b32 v84, s71, v84
  v_and_b32 v85, s71, v85
  v_and_b32 v86, s71, v86
  v_and_b32 v87, s71, v87
  v_and_b32 v88, s71, v88
  v_and_b32 v89, s71, v89
  v_and_b32 v90, s71, v90
  v_and_b32 v91, s71, v91
  v_and_b32 v92, s71, v92
  v_and_b32 v93, s71, v93
  v_and_b32 v94, s71, v94
  v_and_b32 v95, s71, v95
  v_and_b32 v96, s71, v96
  v_and_b32 v97, s71, v97
  v_and_b32 v98, s71, v98
  v_and_b32 v99, s71, v99
  v_and_b32 v100, s71, v100
  v_and_b32 v101, s71, v101
  v_and_b32 v102, s71, v102
  v_and_b32 v103, s71, v103
  v_and_b32 v104, s71, v104
  v_and_b32 v105, s71, v105
  v_and_b32 v106, s71, v106
  v_and_b32 v107, s71, v107
  v_and_b32 v108, s71, v108
  v_and_b32 v109, s71, v109
  v_and_b32 v110, s71, v110
  v_and_b32 v111, s71, v111
  v_and_b32 v112, s71, v112
  v_and_b32 v113, s71, v113
  v_and_b32 v114, s71, v114
  v_and_b32 v115, s71, v115
  v_and_b32 v116, s71, v116
  v_and_b32 v117, s71, v117
  v_and_b32 v118, s71, v118
  v_and_b32 v119, s71, v119
  v_and_b32 v120, s71, v120
  v_and_b32 v121, s71, v121
  v_and_b32 v122, s71, v122
  v_and_b32 v123, s71, v123
  v_and_b32 v124, s71, v124
  v_and_b32 v125, s71, v125
  v_and_b32 v126, s71, v126
  v_and_b32 v127, s71, v127
  v_and_b32 v128, s71, v128
  v_and_b32 v129, s71, v129
  v_and_b32 v130, s71, v130
  v_and_b32 v131, s71, v131
  v_and_b32 v132, s71, v132
  v_and_b32 v133, s71, v133
  v_and_b32 v134, s71, v134
  v_and_b32 v135, s71, v135
  v_and_b32 v136, s71, v136
  v_and_b32 v137, s71, v137
  v_and_b32 v138, s71, v138
  v_and_b32 v139, s71, v139
  v_and_b32 v140, s71, v140
  v_and_b32 v141, s71, v141
  v_and_b32 v142, s71, v142
  v_and_b32 v143, s71, v143
  v_and_b32 v144, s71, v144
  v_and_b32 v145, s71, v145
  v_and_b32 v146, s71, v146
  v_and_b32 v147, s71, v147
  v_and_b32 v148, s71, v148
  v_and_b32 v149, s71, v149
  v_and_b32 v152, s71, v152
  v_and_b32 v153, s71, v153
  v_add_f32 v84, v84, v88
  v_add_f32 v85, v85, v89
  v_add_f32 v86, v86, v90
  v_add_f32 v87, v87, v91
  v_add_f32 v84, v84, v92
  v_add_f32 v85, v85, v93
  v_add_f32 v86, v86, v94
  v_add_f32 v87, v87, v95
  v_add_f32 v84, v84, v96
  v_add_f32 v85, v85, v97
  v_add_f32 v86, v86, v98
  v_add_f32 v87, v87, v99
  v_add_f32 v84, v84, v100
  v_add_f32 v85, v85, v101
  v_add_f32 v86, v86, v102
  v_add_f32 v87, v87, v103
  v_add_f32 v84, v84, v104
  v_add_f32 v85, v85, v105
  v_add_f32 v86, v86, v106
  v_add_f32 v87, v87, v107
  v_add_f32 v84, v84, v108
  v_add_f32 v85, v85, v109
  v_add_f32 v86, v86, v110
  v_add_f32 v87, v87, v111
  v_add_f32 v84, v84, v112
  v_add_f32 v85, v85, v113
  v_add_f32 v86, v86, v114
  v_add_f32 v87, v87, v115
  v_add_f32 v84, v84, v116
  v_add_f32 v85, v85, v117
  v_add_f32 v86, v86, v118
  v_add_f32 v87, v87, v119
  v_add_f32 v84, v84, v120
  v_add_f32 v85, v85, v121
  v_add_f32 v86, v86, v122
  v_add_f32 v87, v87, v123
  v_add_f32 v84, v84, v124
  v_add_f32 v85, v85, v125
  v_add_f32 v86, v86, v126
  v_add_f32 v87, v87, v127
  v_add_f32 v84, v84, v128
  v_add_f32 v85, v85, v129
  v_add_f32 v86, v86, v130
  v_add_f32 v87, v87, v131
  v_add_f32 v84, v84, v132
  v_add_f32 v85, v85, v133
  v_add_f32 v86, v86, v134
  v_add_f32 v87, v87, v135
  v_add_f32 v84, v84, v136
  v_add_f32 v85, v85, v137
  v_add_f32 v86, v86, v138
  v_add_f32 v87, v87, v139
  v_add_f32 v84, v84, v140
  v_add_f32 v85, v85, v141
  v_add_f32 v86, v86, v142
  v_add_f32 v87, v87, v143
  v_add_f32 v84, v84, v144
  v_add_f32 v85, v85, v145
  v_add_f32 v86, v86, v146
  v_add_f32 v87, v87, v147
  v_add_u32 v2, 158720, v14
  ds_write_b128 v2, v[148:151]
  ds_write_b128 v2, v[152:155] offset:1024
  ds_write_b128 v2, v[84:87] offset:2048
  s_waitcnt lgkmcnt(0)
  v_mov_b32 v2, 161792
  v_mov_b32 v3, 1
  s_mov_b64 exec, 1
  ds_add_u32 v2, v3 offset:20
  s_mov_b64 exec, -1
NOPOST_41:
  s_barrier
  s_lshr_b32 s52, s19, 1
  s_lshl_b32 s52, s52, 5
  s_and_b32 s62, s19, 1
  s_lshl_b32 s3, s62, 2
  s_add_u32 s52, s52, s3
  v_lshrrev_b32 v2, 4, v0
  v_bfe_u32 v3, v0, 2, 2
  v_lshl_add_u32 v3, v2, 3, v3
  v_mul_u32_u24 v16, 3072, v3
  v_and_b32 v2, 1, v2
  v_lshlrev_b32 v2, 1, v2
  v_and_b32 v3, 3, v0
  v_xor_b32 v2, v2, v3
  v_lshl_add_u32 v16, v2, 4, v16
  s_and_b32 s62, s19, 1
  s_lshl_b32 s3, s62, 7
  v_add_u32 v2, s3, v0
  v_add_u32 v2, 0, v2
  v_mul_u32_u24 v3, 10923, v2
  v_lshrrev_b32 v3, 16, v3
  v_mul_u32_u24 v4, 6, v3
  v_sub_u32 v4, v2, v4
  v_bfe_u32 v6, v3, 2, 2
  v_lshlrev_b32 v6, 3, v6
  v_lshrrev_b32 v7, 4, v3
  v_lshl_add_u32 v6, v7, 2, v6
  v_and_b32 v7, 3, v3
  v_add_u32 v6, v6, v7
  v_mul_u32_u24 v17, 3584, v6
  v_lshl_add_u32 v17, v4, 4, v17
  v_add_u32 v2, s3, v0
  v_add_u32 v2, 64, v2
  v_mul_u32_u24 v3, 10923, v2
  v_lshrrev_b32 v3, 16, v3
  v_mul_u32_u24 v4, 6, v3
  v_sub_u32 v4, v2, v4
  v_bfe_u32 v6, v3, 2, 2
  v_lshlrev_b32 v6, 3, v6
  v_lshrrev_b32 v7, 4, v3
  v_lshl_add_u32 v6, v7, 2, v6
  v_and_b32 v7, 3, v3
  v_add_u32 v6, v6, v7
  v_mul_u32_u24 v18, 3584, v6
  v_lshl_add_u32 v18, v4, 4, v18
  s_cmp_eq_u32 s62, 1
  s_cselect_b32 s3, 0x80000000, 0
  v_or_b32 v18, s3, v18
  s_lshr_b32 s3, s19, 1
  s_mul_i32 s55, s52, 3072
  s_lshl_b32 s64, s23, 6
  s_add_u32 s55, s55, s64
  s_mul_i32 s56, s3, 114688
  s_mul_i32 s64, s23, 96
  s_add_u32 s56, s56, s64
  s_add_u32 s56, s56, 2048
  s_mul_i32 s57, s3, 5120
  s_lshl_b32 s64, s62, 10
  s_add_u32 s60, s57, s64
  s_lshl_b32 s64, s62, 11
  s_add_u32 s57, s57, s64
  s_add_u32 s64, s57, 1024
  s_cmp_eq_u32 s62, 1
  s_cselect_b32 s64, 8192, s64
  v_mov_b32 v2, 161792
  s_mov_b32 s63, 0x400000
LW_42:
  ds_read_b32 v3, v2 offset:160
  s_sub_u32 s63, s63, 1
  s_waitcnt lgkmcnt(0)
  v_readfirstlane_b32 s62, v3
  s_cmp_eq_u32 s63, 0
  s_cbranch_scc1 LWOK_43
  s_cmp_ge_u32 s62, 4
  s_cbranch_scc1 LWOK_43
  s_sleep 1
  s_branch LW_42
LWOK_43:
  s_add_u32 m0, s60, 147456
  s_add_u32 s74, s55, 196608
  buffer_load_dwordx4 v16, s[28:31], s74 offen  lds
  s_add_u32 m0, s57, 149504
  s_add_u32 s74, s56, 229376
  buffer_load_dwordx4 v17, s[32:35], s74 offen  lds
  s_add_u32 m0, s64, 149504
  s_nop 0
  buffer_load_dwordx4 v18, s[32:35], s74 offen  lds
  v_mov_b32 v2, 161792
  s_mov_b32 s63, 0x400000
LW_44:
  ds_read_b32 v3, v2 offset:164
  s_sub_u32 s63, s63, 1
  s_waitcnt lgkmcnt(0)
  v_readfirstlane_b32 s62, v3
  s_cmp_eq_u32 s63, 0
  s_cbranch_scc1 LWOK_45
  s_cmp_ge_u32 s62, 4
  s_cbranch_scc1 LWOK_45
  s_sleep 1
  s_branch LW_44
LWOK_45:
  s_add_u32 m0, s60, 54272
  s_add_u32 s74, s55, 393216
  buffer_load_dwordx4 v16, s[28:31], s74 offen  lds
  s_add_u32 m0, s57, 56320
  s_add_u32 s74, s56, 458752
  buffer_load_dwordx4 v17, s[32:35], s74 offen  lds
  s_add_u32 m0, s64, 56320
  s_nop 0
  buffer_load_dwordx4 v18, s[32:35], s74 offen  lds
  v_and_b32 v10, 3, v0
  v_min_u32 v10, 2, v10
  s_sub_u32 s76, s20, 2
  v_add_u32 v10, s76, v10
  v_max_i32 v10, 0, v10
  v_lshlrev_b32 v10, 11, v10
  v_bfe_u32 v11, v0, 2, 1
  v_lshl_add_u32 v10, v11, 10, v10
  s_lshr_b32 s76, s23, 1
  s_lshl_b32 s76, s76, 7
  s_add_u32 s76, s76, 0xf90000
  v_mov_b32 v11, s61
  v_lshlrev_b32 v1, 4, v0
  s_lshr_b32 s52, s19, 1
  s_lshl_b32 s53, s23, 1
  s_add_u32 s53, s53, s52
  s_lshl_b32 s53, s53, 6
  s_and_b32 s54, s19, 1
  s_mul_i32 s54, s54, 6
  s_lshl_b32 s55, s20, 2
  s_add_u32 s54, s54, s55
  s_mul_i32 s55, s19, 6144
  buffer_load_dword v4, v10, s[40:43], s76 offen sc1
  s_waitcnt vmcnt(4)
  v_mov_b32 v2, 161792
  v_mov_b32 v3, 1
  s_mov_b64 exec, 1
  ds_add_u32 v2, v3 offset:120
  s_mov_b64 exec, -1
  s_waitcnt vmcnt(1)
  v_mov_b32 v2, 161792
  v_mov_b32 v3, 1
  s_mov_b64 exec, 1
  ds_add_u32 v2, v3 offset:124
  s_mov_b64 exec, -1
  v_mov_b32 v2, 161792
  s_mov_b32 s63, 0x400000
LW_46:
  ds_read_b32 v3, v2 offset:168
  s_sub_u32 s63, s63, 1
  s_waitcnt lgkmcnt(0)
  v_readfirstlane_b32 s62, v3
  s_cmp_eq_u32 s63, 0
  s_cbranch_scc1 LWOK_47
  s_cmp_ge_u32 s62, 4
  s_cbranch_scc1 LWOK_47
  s_sleep 1
  s_branch LW_46
LWOK_47:
  s_waitcnt vmcnt(0)
  v_cmp_ne_u32 vcc, v11, v4
  s_nop 1
  s_cmp_eq_u64 vcc, 0
  s_cbranch_scc1 AOK_48
  s_mov_b32 s63, 0x40000
POLL_49:
  buffer_load_dword v4, v10, s[40:43], s76 offen sc1
  s_waitcnt vmcnt(0) lgkmcnt(0)
  v_cmp_ne_u32 vcc, v11, v4
  s_sub_u32 s63, s63, 1
  s_cmp_eq_u32 s63, 0
  s_cbranch_scc1 POLLED_50
  s_cmp_lg_u64 vcc, 0
  s_cbranch_scc1 POLL_49
POLLED_50:
AOK_48:
  s_add_u32 s68, s54, 0
  s_sub_i32 s68, s68, 8
  s_max_i32 s68, s68, 0
  s_add_u32 s68, s68, s53
  s_lshl_b32 s68, s68, 10
  s_add_u32 m0, s55, 65536
  s_add_u32 s69, s68, 0x200000
  buffer_load_dwordx4 v1, s[40:43], s68 offen sc1 lds
  s_add_u32 m0, s55, 90112
  s_nop 0
  buffer_load_dwordx4 v1, s[40:43], s69 offen sc1 lds
  s_add_u32 s68, s54, 1
  s_sub_i32 s68, s68, 8
  s_max_i32 s68, s68, 0
  s_add_u32 s68, s68, s53
  s_lshl_b32 s68, s68, 10
  s_add_u32 m0, s55, 66560
  s_add_u32 s69, s68, 0x200000
  buffer_load_dwordx4 v1, s[40:43], s68 offen sc1 lds
  s_add_u32 m0, s55, 91136
  s_nop 0
  buffer_load_dwordx4 v1, s[40:43], s69 offen sc1 lds
  s_add_u32 s68, s54, 2
  s_sub_i32 s68, s68, 8
  s_max_i32 s68, s68, 0
  s_add_u32 s68, s68, s53
  s_lshl_b32 s68, s68, 10
  s_add_u32 m0, s55, 67584
  s_add_u32 s69, s68, 0x200000
  buffer_load_dwordx4 v1, s[40:43], s68 offen sc1 lds
  s_add_u32 m0, s55, 92160
  s_nop 0
  buffer_load_dwordx4 v1, s[40:43], s69 offen sc1 lds
  s_add_u32 s68, s54, 3
  s_sub_i32 s68, s68, 8
  s_max_i32 s68, s68, 0
  s_add_u32 s68, s68, s53
  s_lshl_b32 s68, s68, 10
  s_add_u32 m0, s55, 68608
  s_add_u32 s69, s68, 0x200000
  buffer_load_dwordx4 v1, s[40:43], s68 offen sc1 lds
  s_add_u32 m0, s55, 93184
  s_nop 0
  buffer_load_dwordx4 v1, s[40:43], s69 offen sc1 lds
  s_add_u32 s68, s54, 4
  s_sub_i32 s68, s68, 8
  s_max_i32 s68, s68, 0
  s_add_u32 s68, s68, s53
  s_lshl_b32 s68, s68, 10
  s_add_u32 m0, s55, 69632
  s_add_u32 s69, s68, 0x200000
  buffer_load_dwordx4 v1, s[40:43], s68 offen sc1 lds
  s_add_u32 m0, s55, 94208
  s_nop 0
  buffer_load_dwordx4 v1, s[40:43], s69 offen sc1 lds
  s_add_u32 s68, s54, 5
  s_sub_i32 s68, s68, 8
  s_max_i32 s68, s68, 0
  s_add_u32 s68, s68, s53
  s_lshl_b32 s68, s68, 10
  s_add_u32 m0, s55, 70656
  s_add_u32 s69, s68, 0x200000
  buffer_load_dwordx4 v1, s[40:43], s68 offen sc1 lds
  s_add_u32 m0, s55, 95232
  s_nop 0
  buffer_load_dwordx4 v1, s[40:43], s69 offen sc1 lds
  v_mov_b32 v2, 161792
  s_mov_b32 s63, 0x400000
LW_51:
  ds_read_b32 v3, v2 offset:184
  s_sub_u32 s63, s63, 1
  s_waitcnt lgkmcnt(0)
  v_readfirstlane_b32 s62, v3
  s_cmp_eq_u32 s63, 0
  s_cbranch_scc1 LWOK_52
  s_cmp_ge_u32 s62, 4
  s_cbranch_scc1 LWOK_52
  s_sleep 1
  s_branch LW_51
LWOK_52:
  v_add_u32 v2, 155648, v1
  v_mov_b32 v8, 0x3f803f80
  v_mov_b32 v9, 0x3f803f80
  v_mov_b32 v10, 0x3f803f80
  v_mov_b32 v11, 0x3f803f80
  ds_write_b128 v2, v[8:11]
  s_mov_b32 s64, 0xffffffff
  s_mov_b32 s65, 0xfffffff0
  s_mov_b32 s66, 0xfffffffe
  s_mov_b32 s67, 0xffffffe0
  s_mov_b32 s68, 0xfffffffc
  s_mov_b32 s69, 0xffffffc0
  s_mov_b32 s70, 0xfffffff8
  s_mov_b32 s71, 0xffffff80
  s_mov_b32 s72, 0xffffff00
  s_mov_b32 s73, 0xfffff000
  s_mov_b32 s74, 0xfffffe00
  s_mov_b32 s75, 0xffffe000
  s_mov_b32 s76, 0xfffffc00
  s_mov_b32 s77, 0xffffc000
  s_mov_b32 s78, 0xfffff800
  s_mov_b32 s79, 0xffff8000
  s_mov_b32 s80, 0xffff0000
  s_mov_b32 s81, 0xfff00000
  s_mov_b32 s82, 0xfffe0000
  s_mov_b32 s83, 0xffe00000
  s_mov_b32 s84, 0xfffc0000
  s_mov_b32 s85, 0xffc00000
  s_mov_b32 s86, 0xfff80000
  s_mov_b32 s87, 0xff800000
  s_mov_b32 s88, 0xff000000
  s_mov_b32 s89, 0xf0000000
  s_mov_b32 s90, 0xfe000000
  s_mov_b32 s91, 0xe0000000
  s_mov_b32 s92, 0xfc000000
  s_mov_b32 s93, 0xc0000000
  s_mov_b32 s94, 0xf8000000
  s_mov_b32 s95, 0x80000000
  v_mov_b32 v6, 0xffff
  v_mov_b32 v7, 0xffff0000
  v_cndmask_b32 v140, 0, v6, s[64:65]
  v_cndmask_b32 v12, 0, v7, s[66:67]
  v_or_b32 v140, v140, v12
  v_cndmask_b32 v141, 0, v6, s[68:69]
  v_cndmask_b32 v12, 0, v7, s[70:71]
  v_or_b32 v141, v141, v12
  v_cndmask_b32 v142, 0, v6, s[72:73]
  v_cndmask_b32 v12, 0, v7, s[74:75]
  v_or_b32 v142, v142, v12
  v_cndmask_b32 v143, 0, v6, s[76:77]
  v_cndmask_b32 v12, 0, v7, s[78:79]
  v_or_b32 v143, v143, v12
  v_cndmask_b32 v144, 0, v6, s[80:81]
  v_cndmask_b32 v12, 0, v7, s[82:83]
  v_or_b32 v144, v144, v12
  v_cndmask_b32 v145, 0, v6, s[84:85]
  v_cndmask_b32 v12, 0, v7, s[86:87]
  v_or_b32 v145, v145, v12
  v_cndmask_b32 v146, 0, v6, s[88:89]
  v_cndmask_b32 v12, 0, v7, s[90:91]
  v_or_b32 v146, v146, v12
  v_cndmask_b32 v147, 0, v6, s[92:93]
  v_cndmask_b32 v12, 0, v7, s[94:95]
  v_or_b32 v147, v147, v12
  ds_write_b128 v2, v[140:143] offset:1024
  ds_write_b128 v2, v[144:147] offset:2048
  s_add_u32 s96, s19, 4
  s_mov_b32 s97, 0
  s_waitcnt vmcnt(0) lgkmcnt(0)
  v_mov_b32 v2, 161792
  v_mov_b32 v3, 1
  s_mov_b64 exec, 1
  ds_add_u32 v2, v3 offset:16
  s_mov_b64 exec, -1
  s_branch L_ATT
.p2align 7
L_CONS:
  s_cmp_lg_u32 s18, 4
  s_cbranch_scc1 L_NOPE
  s_getpc_b64 s[72:73]
L_PCREF2:
  s_sub_u32 s72, s72, L_PCREF2-parallel_sum__sliding_block__dense_activation_relu__prompt_kernel
  s_subb_u32 s73, s73, 0
  s_lshr_b32 s74, s2, 3
  s_and_b32 s74, s74, 7
  s_mul_i32 s74, s74, (L_END0-parallel_sum__sliding_block__dense_activation_relu__prompt_kernel+4095)/4096*128*4
  v_lshlrev_b32 v2, 7, v0
  v_add_u32 v2, s74, v2
  v_min_u32 v2, L_END0-parallel_sum__sliding_block__dense_activation_relu__prompt_kernel, v2
  v_mov_b32 v3, s73
  v_add_co_u32 v2, vcc, s72, v2
  s_nop 1
  v_addc_co_u32 v3, vcc, 0, v3, vcc
  v_cmp_gt_u32 vcc, (L_END0-parallel_sum__sliding_block__dense_activation_relu__prompt_kernel+4095)/4096*4, v0
  s_nop 1
  s_and_saveexec_b64 s[74:75], vcc
  global_load_dword v164, v[2:3], off
  s_mov_b64 exec, -1
L_NOPE:
  s_and_b32 s23, s2, 3
  s_lshl_b32 s23, s23, 2
  s_bfe_u32 s3, s2, 0x20003
  s_add_u32 s23, s23, s3
  s_and_b32 s19, s18, 3
  s_xor_b32 s22, s23, 1
  s_lshl_b32 s24, s20, 4
  s_add_u32 s24, s24, s23
  s_lshl_b32 s24, s24, 7
  s_lshl_b32 s58, s20, 1
  s_lshr_b32 s59, s23, 3
  s_add_u32 s58, s58, s59
  s_and_b32 s59, s23, 7
  s_xor_b32 s59, s59, 2
  s_waitcnt lgkmcnt(0)
  s_mov_b32 s36, s4
  s_and_b32 s37, s5, 0xffff
  s_mov_b32 s38, 0x200000
  s_mov_b32 s39, 0x20000
  s_mov_b32 s40, s16
  s_and_b32 s41, s17, 0xffff
  s_mov_b32 s42, 0x1000000
  s_mov_b32 s43, 0x20000
  v_lshrrev_b32 v8, 2, v0
  v_lshrrev_b32 v9, 3, v8
  v_lshlrev_b32 v9, 11, v9
  v_and_b32 v10, 7, v8
  v_lshl_add_u32 v9, v10, 7, v9
  v_and_b32 v10, 3, v0
  v_lshlrev_b32 v10, 3, v10
  v_add_u32 v9, v9, v10
  v_bfe_u32 v11, v0, 3, 2
  v_lshl_add_u32 v1, v11, 5, v9
  v_add_u32 v1, 98304, v1
  v_xor_b32 v2, 32, v1
  v_xor_b32 v3, 64, v1
  v_xor_b32 v4, 96, v1
  v_and_b32 v8, 15, v0
  v_lshrrev_b32 v9, 4, v0
  v_lshrrev_b32 v10, 1, v8
  v_xor_b32 v9, v9, v10
  v_lshlrev_b32 v8, 7, v8
  v_lshl_add_u32 v7, v9, 4, v8
  s_lshl_b32 s3, s19, 12
  s_add_u32 s3, s3, 49152
  v_add_u32 v7, s3, v7
  v_xor_b32 v5, 64, v7
  v_mov_b32 v6, 161792
  v_mov_b32 v165, 1
  s_mov_b32 s64, 0xffffffff
  s_mov_b32 s65, 0xfffffff0
  s_mov_b32 s66, 0xfffffffe
  s_mov_b32 s67, 0xffffffe0
  s_mov_b32 s68, 0xfffffffc
  s_mov_b32 s69, 0xffffffc0
  s_mov_b32 s70, 0xfffffff8
  s_mov_b32 s71, 0xffffff80
  s_mov_b32 s72, 0xffffff00
  s_mov_b32 s73, 0xfffff000
  s_mov_b32 s74, 0xfffffe00
  s_mov_b32 s75, 0xffffe000
  s_mov_b32 s76, 0xfffffc00
  s_mov_b32 s77, 0xffffc000
  s_mov_b32 s78, 0xfffff800
  s_mov_b32 s79, 0xffff8000
  s_mov_b32 s80, 0xffff0000
  s_mov_b32 s81, 0xfff00000
  s_mov_b32 s82, 0xfffe0000
  s_mov_b32 s83, 0xffe00000
  s_mov_b32 s84, 0xfffc0000
  s_mov_b32 s85, 0xffc00000
  s_mov_b32 s86, 0xfff80000
  s_mov_b32 s87, 0xff800000
  s_mov_b32 s88, 0xff000000
  s_mov_b32 s89, 0xf0000000
  s_mov_b32 s90, 0xfe000000
  s_mov_b32 s91, 0xe0000000
  s_mov_b32 s92, 0xfc000000
  s_mov_b32 s93, 0xc0000000
  s_mov_b32 s94, 0xf8000000
  s_mov_b32 s95, 0x80000000
  s_setprio 3
  s_barrier
  ds_read_b128 v[48:51], v7 offset:0
  ds_read_b128 v[52:55], v7 offset:2048
  ds_read_b64_tr_b16 v[8:9], v1 offset:0
  ds_read_b64_tr_b16 v[10:11], v1 offset:4096
  ds_read_b64_tr_b16 v[12:13], v2 offset:0
  ds_read_b64_tr_b16 v[14:15], v2 offset:4096
  ds_read_b64_tr_b16 v[16:17], v3 offset:0
  ds_read_b64_tr_b16 v[18:19], v3 offset:4096
  ds_read_b64_tr_b16 v[20:21], v4 offset:0
  ds_read_b64_tr_b16 v[22:23], v4 offset:4096
  ds_read_b64_tr_b16 v[24:25], v1 offset:1024
  ds_read_b64_tr_b16 v[26:27], v1 offset:5120
  s_waitcnt lgkmcnt(6)
  v_mfma_f32_16x16x32_bf16 v[96:99], v[8:11], v[48:51], 0
  ds_read_b64_tr_b16 v[28:29], v2 offset:1024
  v_mfma_f32_16x16x32_bf16 v[100:103], v[8:11], v[52:55], 0
  ds_read_b64_tr_b16 v[30:31], v2 offset:5120
  v_mfma_f32_16x16x32_bf16 v[104:107], v[12:15], v[48:51], 0
  ds_read_b64_tr_b16 v[8:9], v3 offset:1024
  v_mfma_f32_16x16x32_bf16 v[108:111], v[12:15], v[52:55], 0
  ds_read_b64_tr_b16 v[10:11], v3 offset:5120
  s_waitcnt lgkmcnt(6)
  v_mfma_f32_16x16x32_bf16 v[112:115], v[16:19], v[48:51], 0
  ds_read_b64_tr_b16 v[12:13], v4 offset:1024
  v_mfma_f32_16x16x32_bf16 v[116:119], v[16:19], v[52:55], 0
  ds_read_b64_tr_b16 v[14:15], v4 offset:5120
  ds_read_b128 v[56:59], v5 offset:0
  ds_read_b128 v[60:63], v5 offset:2048
  v_mfma_f32_16x16x32_bf16 v[120:123], v[20:23], v[48:51], 0
  ds_read_b64_tr_b16 v[16:17], v1 offset:8192
  v_mfma_f32_16x16x32_bf16 v[124:127], v[20:23], v[52:55], 0
  ds_read_b64_tr_b16 v[18:19], v1 offset:12288
  s_waitcnt lgkmcnt(8)
  v_mfma_f32_16x16x32_bf16 v[128:131], v[24:27], v[48:51], 0
  ds_read_b64_tr_b16 v[20:21], v2 offset:8192
  v_mfma_f32_16x16x32_bf16 v[132:135], v[24:27], v[52:55], 0
  ds_read_b64_tr_b16 v[22:23], v2 offset:12288
  v_mfma_f32_16x16x32_bf16 v[136:139], v[28:31], v[48:51], 0
  ds_read_b64_tr_b16 v[24:25], v3 offset:8192
  v_mfma_f32_16x16x32_bf16 v[140:143], v[28:31], v[52:55], 0
  ds_read_b64_tr_b16 v[26:27], v3 offset:12288
  s_waitcnt lgkmcnt(8)
  v_mfma_f32_16x16x32_bf16 v[144:147], v[8:11], v[48:51], 0
  ds_read_b64_tr_b16 v[28:29], v4 offset:8192
  v_mfma_f32_16x16x32_bf16 v[148:151], v[8:11], v[52:55], 0
  ds_read_b64_tr_b16 v[30:31], v4 offset:12288
  v_mfma_f32_16x16x32_bf16 v[152:155], v[12:15], v[48:51], 0
  ds_read_b64_tr_b16 v[8:9], v1 offset:9216
  v_mfma_f32_16x16x32_bf16 v[156:159], v[12:15], v[52:55], 0
  ds_read_b64_tr_b16 v[10:11], v1 offset:13312
  s_waitcnt lgkmcnt(6)
  v_mfma_f32_16x16x32_bf16 v[96:99], v[16:19], v[56:59], v[96:99]
  ds_read_b64_tr_b16 v[12:13], v2 offset:9216
  v_mfma_f32_16x16x32_bf16 v[100:103], v[16:19], v[60:63], v[100:103]
  ds_read_b64_tr_b16 v[14:15], v2 offset:13312
  v_mfma_f32_16x16x32_bf16 v[104:107], v[20:23], v[56:59], v[104:107]
  ds_read_b64_tr_b16 v[16:17], v3 offset:9216
  v_mfma_f32_16x16x32_bf16 v[108:111], v[20:23], v[60:63], v[108:111]
  ds_read_b64_tr_b16 v[18:19], v3 offset:13312
  s_waitcnt lgkmcnt(6)
  v_mfma_f32_16x16x32_bf16 v[112:115], v[24:27], v[56:59], v[112:115]
  ds_read_b64_tr_b16 v[20:21], v4 offset:9216
  v_mfma_f32_16x16x32_bf16 v[116:119], v[24:27], v[60:63], v[116:119]
  ds_read_b64_tr_b16 v[22:23], v4 offset:13312
  v_add_u32 v1, 0x4000, v1
  v_add_u32 v2, 0x4000, v2
  v_add_u32 v3, 0x4000, v3
  v_add_u32 v4, 0x4000, v4
  s_barrier
  v_add_u32 v7, 0xffffc000, v7
  v_add_u32 v5, 0xffffc000, v5
  ds_read_b128 v[64:67], v7 offset:0
  ds_read_b128 v[68:71], v7 offset:2048
  v_mfma_f32_16x16x32_bf16 v[120:123], v[28:31], v[56:59], v[120:123]
  ds_read_b64_tr_b16 v[24:25], v1 offset:0
  v_mfma_f32_16x16x32_bf16 v[124:127], v[28:31], v[60:63], v[124:127]
  ds_read_b64_tr_b16 v[26:27], v1 offset:4096
  s_waitcnt lgkmcnt(8)
  v_mfma_f32_16x16x32_bf16 v[128:131], v[8:11], v[56:59], v[128:131]
  ds_read_b64_tr_b16 v[28:29], v2 offset:0
  v_mfma_f32_16x16x32_bf16 v[132:135], v[8:11], v[60:63], v[132:135]
  ds_read_b64_tr_b16 v[30:31], v2 offset:4096
  v_mfma_f32_16x16x32_bf16 v[136:139], v[12:15], v[56:59], v[136:139]
  ds_read_b64_tr_b16 v[8:9], v3 offset:0
  v_mfma_f32_16x16x32_bf16 v[140:143], v[12:15], v[60:63], v[140:143]
  ds_read_b64_tr_b16 v[10:11], v3 offset:4096
  s_waitcnt lgkmcnt(8)
  v_mfma_f32_16x16x32_bf16 v[144:147], v[16:19], v[56:59], v[144:147]
  ds_read_b64_tr_b16 v[12:13], v4 offset:0
  v_mfma_f32_16x16x32_bf16 v[148:151], v[16:19], v[60:63], v[148:151]
  ds_read_b64_tr_b16 v[14:15], v4 offset:4096
  v_mfma_f32_16x16x32_bf16 v[152:155], v[20:23], v[56:59], v[152:155]
  ds_read_b64_tr_b16 v[16:17], v1 offset:1024
  v_mfma_f32_16x16x32_bf16 v[156:159], v[20:23], v[60:63], v[156:159]
  ds_read_b64_tr_b16 v[18:19], v1 offset:5120
  s_waitcnt lgkmcnt(6)
  v_mfma_f32_16x16x32_bf16 v[96:99], v[24:27], v[64:67], v[96:99]
  ds_read_b64_tr_b16 v[20:21], v2 offset:1024
  v_mfma_f32_16x16x32_bf16 v[100:103], v[24:27], v[68:71], v[100:103]
  ds_read_b64_tr_b16 v[22:23], v2 offset:5120
  v_mfma_f32_16x16x32_bf16 v[104:107], v[28:31], v[64:67], v[104:107]
  ds_read_b64_tr_b16 v[24:25], v3 offset:1024
  v_mfma_f32_16x16x32_bf16 v[108:111], v[28:31], v[68:71], v[108:111]
  ds_read_b64_tr_b16 v[26:27], v3 offset:5120
  s_waitcnt lgkmcnt(6)
  v_mfma_f32_16x16x32_bf16 v[112:115], v[8:11], v[64:67], v[112:115]
  ds_read_b64_tr_b16 v[28:29], v4 offset:1024
  v_mfma_f32_16x16x32_bf16 v[116:119], v[8:11], v[68:71], v[116:119]
  ds_read_b64_tr_b16 v[30:31], v4 offset:5120
  ds_read_b128 v[72:75], v5 offset:0
  ds_read_b128 v[76:79], v5 offset:2048
  v_mfma_f32_16x16x32_bf16 v[120:123], v[12:15], v[64:67], v[120:123]
  ds_read_b64_tr_b16 v[8:9], v1 offset:8192
  v_mfma_f32_16x16x32_bf16 v[124:127], v[12:15], v[68:71], v[124:127]
  ds_read_b64_tr_b16 v[10:11], v1 offset:12288
  s_waitcnt lgkmcnt(8)
  v_mfma_f32_16x16x32_bf16 v[128:131], v[16:19], v[64:67], v[128:131]
  ds_read_b64_tr_b16 v[12:13], v2 offset:8192
  v_mfma_f32_16x16x32_bf16 v[132:135], v[16:19], v[68:71], v[132:135]
  ds_read_b64_tr_b16 v[14:15], v2 offset:12288
  v_mfma_f32_16x16x32_bf16 v[136:139], v[20:23], v[64:67], v[136:139]
  ds_read_b64_tr_b16 v[16:17], v3 offset:8192
  v_mfma_f32_16x16x32_bf16 v[140:143], v[20:23], v[68:71], v[140:143]
  ds_read_b64_tr_b16 v[18:19], v3 offset:12288
  s_waitcnt lgkmcnt(8)
  v_mfma_f32_16x16x32_bf16 v[144:147], v[24:27], v[64:67], v[144:147]
  ds_read_b64_tr_b16 v[20:21], v4 offset:8192
  v_mfma_f32_16x16x32_bf16 v[148:151], v[24:27], v[68:71], v[148:151]
  ds_read_b64_tr_b16 v[22:23], v4 offset:12288
  v_mfma_f32_16x16x32_bf16 v[152:155], v[28:31], v[64:67], v[152:155]
  ds_read_b64_tr_b16 v[24:25], v1 offset:9216
  v_mfma_f32_16x16x32_bf16 v[156:159], v[28:31], v[68:71], v[156:159]
  ds_read_b64_tr_b16 v[26:27], v1 offset:13312
  s_waitcnt lgkmcnt(6)
  v_mfma_f32_16x16x32_bf16 v[96:99], v[8:11], v[72:75], v[96:99]
  ds_read_b64_tr_b16 v[28:29], v2 offset:9216
  v_mfma_f32_16x16x32_bf16 v[100:103], v[8:11], v[76:79], v[100:103]
  ds_read_b64_tr_b16 v[30:31], v2 offset:13312
  v_mfma_f32_16x16x32_bf16 v[104:107], v[12:15], v[72:75], v[104:107]
  ds_read_b64_tr_b16 v[8:9], v3 offset:9216
  v_mfma_f32_16x16x32_bf16 v[108:111], v[12:15], v[76:79], v[108:111]
  ds_read_b64_tr_b16 v[10:11], v3 offset:13312
  s_waitcnt lgkmcnt(6)
  v_mfma_f32_16x16x32_bf16 v[112:115], v[16:19], v[72:75], v[112:115]
  ds_read_b64_tr_b16 v[12:13], v4 offset:9216
  v_mfma_f32_16x16x32_bf16 v[116:119], v[16:19], v[76:79], v[116:119]
  ds_read_b64_tr_b16 v[14:15], v4 offset:13312
  v_add_u32 v1, 0xfffe8000, v1
  v_add_u32 v2, 0xfffe8000, v2
  v_add_u32 v3, 0xfffe8000, v3
  v_add_u32 v4, 0xfffe8000, v4
  s_barrier
  v_add_u32 v7, 0x18000, v7
  v_add_u32 v5, 0x18000, v5
  ds_read_b128 v[80:83], v7 offset:0
  ds_read_b128 v[84:87], v7 offset:2048
  v_mfma_f32_16x16x32_bf16 v[120:123], v[20:23], v[72:75], v[120:123]
  ds_read_b64_tr_b16 v[16:17], v1 offset:0
  v_mfma_f32_16x16x32_bf16 v[124:127], v[20:23], v[76:79], v[124:127]
  ds_read_b64_tr_b16 v[18:19], v1 offset:4096
  s_waitcnt lgkmcnt(8)
  v_mfma_f32_16x16x32_bf16 v[128:131], v[24:27], v[72:75], v[128:131]
  ds_read_b64_tr_b16 v[20:21], v2 offset:0
  v_mfma_f32_16x16x32_bf16 v[132:135], v[24:27], v[76:79], v[132:135]
  ds_read_b64_tr_b16 v[22:23], v2 offset:4096
  v_mfma_f32_16x16x32_bf16 v[136:139], v[28:31], v[72:75], v[136:139]
  ds_read_b64_tr_b16 v[24:25], v3 offset:0
  v_mfma_f32_16x16x32_bf16 v[140:143], v[28:31], v[76:79], v[140:143]
  ds_read_b64_tr_b16 v[26:27], v3 offset:4096
  s_waitcnt lgkmcnt(8)
  v_mfma_f32_16x16x32_bf16 v[144:147], v[8:11], v[72:75], v[144:147]
  ds_read_b64_tr_b16 v[28:29], v4 offset:0
  v_mfma_f32_16x16x32_bf16 v[148:151], v[8:11], v[76:79], v[148:151]
  ds_read_b64_tr_b16 v[30:31], v4 offset:4096
  v_mfma_f32_16x16x32_bf16 v[152:155], v[12:15], v[72:75], v[152:155]
  ds_read_b64_tr_b16 v[8:9], v1 offset:1024
  v_mfma_f32_16x16x32_bf16 v[156:159], v[12:15], v[76:79], v[156:159]
  ds_read_b64_tr_b16 v[10:11], v1 offset:5120
  s_waitcnt lgkmcnt(6)
  v_mfma_f32_16x16x32_bf16 v[96:99], v[16:19], v[80:83], v[96:99]
  ds_read_b64_tr_b16 v[12:13], v2 offset:1024
  v_mfma_f32_16x16x32_bf16 v[100:103], v[16:19], v[84:87], v[100:103]
  ds_read_b64_tr_b16 v[14:15], v2 offset:5120
  v_mfma_f32_16x16x32_bf16 v[104:107], v[20:23], v[80:83], v[104:107]
  ds_read_b64_tr_b16 v[16:17], v3 offset:1024
  v_mfma_f32_16x16x32_bf16 v[108:111], v[20:23], v[84:87], v[108:111]
  ds_read_b64_tr_b16 v[18:19], v3 offset:5120
  s_waitcnt lgkmcnt(6)
  v_mfma_f32_16x16x32_bf16 v[112:115], v[24:27], v[80:83], v[112:115]
  ds_read_b64_tr_b16 v[20:21], v4 offset:1024
  v_mfma_f32_16x16x32_bf16 v[116:119], v[24:27], v[84:87], v[116:119]
  ds_read_b64_tr_b16 v[22:23], v4 offset:5120
  ds_read_b128 v[88:91], v5 offset:0
  ds_read_b128 v[92:95], v5 offset:2048
  v_mfma_f32_16x16x32_bf16 v[120:123], v[28:31], v[80:83], v[120:123]
  ds_read_b64_tr_b16 v[24:25], v1 offset:8192
  v_mfma_f32_16x16x32_bf16 v[124:127], v[28:31], v[84:87], v[124:127]
  ds_read_b64_tr_b16 v[26:27], v1 offset:12288
  s_waitcnt lgkmcnt(8)
  v_mfma_f32_16x16x32_bf16 v[128:131], v[8:11], v[80:83], v[128:131]
  ds_read_b64_tr_b16 v[28:29], v2 offset:8192
  v_mfma_f32_16x16x32_bf16 v[132:135], v[8:11], v[84:87], v[132:135]
  ds_read_b64_tr_b16 v[30:31], v2 offset:12288
  v_mfma_f32_16x16x32_bf16 v[136:139], v[12:15], v[80:83], v[136:139]
  ds_read_b64_tr_b16 v[8:9], v3 offset:8192
  v_mfma_f32_16x16x32_bf16 v[140:143], v[12:15], v[84:87], v[140:143]
  ds_read_b64_tr_b16 v[10:11], v3 offset:12288
  s_waitcnt lgkmcnt(8)
  v_mfma_f32_16x16x32_bf16 v[144:147], v[16:19], v[80:83], v[144:147]
  ds_read_b64_tr_b16 v[12:13], v4 offset:8192
  v_mfma_f32_16x16x32_bf16 v[148:151], v[16:19], v[84:87], v[148:151]
  ds_read_b64_tr_b16 v[14:15], v4 offset:12288
  v_mfma_f32_16x16x32_bf16 v[152:155], v[20:23], v[80:83], v[152:155]
  ds_read_b64_tr_b16 v[16:17], v1 offset:9216
  v_mfma_f32_16x16x32_bf16 v[156:159], v[20:23], v[84:87], v[156:159]
  ds_read_b64_tr_b16 v[18:19], v1 offset:13312
  s_waitcnt lgkmcnt(6)
  v_mfma_f32_16x16x32_bf16 v[96:99], v[24:27], v[88:91], v[96:99]
  ds_read_b64_tr_b16 v[20:21], v2 offset:9216
  v_mfma_f32_16x16x32_bf16 v[100:103], v[24:27], v[92:95], v[100:103]
  ds_read_b64_tr_b16 v[22:23], v2 offset:13312
  v_mfma_f32_16x16x32_bf16 v[104:107], v[28:31], v[88:91], v[104:107]
  ds_read_b64_tr_b16 v[24:25], v3 offset:9216
  v_mfma_f32_16x16x32_bf16 v[108:111], v[28:31], v[92:95], v[108:111]
  ds_read_b64_tr_b16 v[26:27], v3 offset:13312
  s_waitcnt lgkmcnt(6)
  v_mfma_f32_16x16x32_bf16 v[112:115], v[8:11], v[88:91], v[112:115]
  ds_read_b64_tr_b16 v[28:29], v4 offset:9216
  v_mfma_f32_16x16x32_bf16 v[116:119], v[8:11], v[92:95], v[116:119]
  ds_read_b64_tr_b16 v[30:31], v4 offset:13312
  v_add_u32 v1, 0xffffc000, v1
  v_add_u32 v2, 0xffffc000, v2
  v_add_u32 v3, 0xffffc000, v3
  v_add_u32 v4, 0xffffc000, v4
  s_barrier
  v_add_u32 v7, 0xffff0000, v7
  v_add_u32 v5, 0xffff0000, v5
  ds_read_b128 v[32:35], v7 offset:0
  ds_read_b128 v[36:39], v7 offset:2048
  v_mfma_f32_16x16x32_bf16 v[120:123], v[12:15], v[88:91], v[120:123]
  ds_read_b64_tr_b16 v[8:9], v1 offset:0
  v_mfma_f32_16x16x32_bf16 v[124:127], v[12:15], v[92:95], v[124:127]
  ds_read_b64_tr_b16 v[10:11], v1 offset:4096
  s_waitcnt lgkmcnt(8)
  v_mfma_f32_16x16x32_bf16 v[128:131], v[16:19], v[88:91], v[128:131]
  ds_read_b64_tr_b16 v[12:13], v2 offset:0
  v_mfma_f32_16x16x32_bf16 v[132:135], v[16:19], v[92:95], v[132:135]
  ds_read_b64_tr_b16 v[14:15], v2 offset:4096
  v_mfma_f32_16x16x32_bf16 v[136:139], v[20:23], v[88:91], v[136:139]
  ds_read_b64_tr_b16 v[16:17], v3 offset:0
  v_mfma_f32_16x16x32_bf16 v[140:143], v[20:23], v[92:95], v[140:143]
  ds_read_b64_tr_b16 v[18:19], v3 offset:4096
  s_waitcnt lgkmcnt(8)
  v_mfma_f32_16x16x32_bf16 v[144:147], v[24:27], v[88:91], v[144:147]
  ds_read_b64_tr_b16 v[20:21], v4 offset:0
  v_mfma_f32_16x16x32_bf16 v[148:151], v[24:27], v[92:95], v[148:151]
  ds_read_b64_tr_b16 v[22:23], v4 offset:4096
  v_mfma_f32_16x16x32_bf16 v[152:155], v[28:31], v[88:91], v[152:155]
  ds_read_b64_tr_b16 v[24:25], v1 offset:1024
  v_mfma_f32_16x16x32_bf16 v[156:159], v[28:31], v[92:95], v[156:159]
  ds_read_b64_tr_b16 v[26:27], v1 offset:5120
  s_waitcnt lgkmcnt(6)
  v_mfma_f32_16x16x32_bf16 v[96:99], v[8:11], v[32:35], v[96:99]
  ds_read_b64_tr_b16 v[28:29], v2 offset:1024
  v_mfma_f32_16x16x32_bf16 v[100:103], v[8:11], v[36:39], v[100:103]
  ds_read_b64_tr_b16 v[30:31], v2 offset:5120
  v_mfma_f32_16x16x32_bf16 v[104:107], v[12:15], v[32:35], v[104:107]
  ds_read_b64_tr_b16 v[8:9], v3 offset:1024
  v_mfma_f32_16x16x32_bf16 v[108:111], v[12:15], v[36:39], v[108:111]
  ds_read_b64_tr_b16 v[10:11], v3 offset:5120
  s_waitcnt lgkmcnt(6)
  v_mfma_f32_16x16x32_bf16 v[112:115], v[16:19], v[32:35], v[112:115]
  ds_read_b64_tr_b16 v[12:13], v4 offset:1024
  v_mfma_f32_16x16x32_bf16 v[116:119], v[16:19], v[36:39], v[116:119]
  ds_read_b64_tr_b16 v[14:15], v4 offset:5120
  ds_read_b128 v[40:43], v5 offset:0
  ds_read_b128 v[44:47], v5 offset:2048
  v_mfma_f32_16x16x32_bf16 v[120:123], v[20:23], v[32:35], v[120:123]
  ds_read_b64_tr_b16 v[16:17], v1 offset:8192
  v_mfma_f32_16x16x32_bf16 v[124:127], v[20:23], v[36:39], v[124:127]
  ds_read_b64_tr_b16 v[18:19], v1 offset:12288
  s_waitcnt lgkmcnt(8)
  v_mfma_f32_16x16x32_bf16 v[128:131], v[24:27], v[32:35], v[128:131]
  ds_read_b64_tr_b16 v[20:21], v2 offset:8192
  v_mfma_f32_16x16x32_bf16 v[132:135], v[24:27], v[36:39], v[132:135]
  ds_read_b64_tr_b16 v[22:23], v2 offset:12288
  v_mfma_f32_16x16x32_bf16 v[136:139], v[28:31], v[32:35], v[136:139]
  ds_read_b64_tr_b16 v[24:25], v3 offset:8192
  v_mfma_f32_16x16x32_bf16 v[140:143], v[28:31], v[36:39], v[140:143]
  ds_read_b64_tr_b16 v[26:27], v3 offset:12288
  s_waitcnt lgkmcnt(8)
  v_mfma_f32_16x16x32_bf16 v[144:147], v[8:11], v[32:35], v[144:147]
  ds_read_b64_tr_b16 v[28:29], v4 offset:8192
  v_mfma_f32_16x16x32_bf16 v[148:151], v[8:11], v[36:39], v[148:151]
  ds_read_b64_tr_b16 v[30:31], v4 offset:12288
  v_mfma_f32_16x16x32_bf16 v[152:155], v[12:15], v[32:35], v[152:155]
  ds_read_b64_tr_b16 v[8:9], v1 offset:9216
  v_mfma_f32_16x16x32_bf16 v[156:159], v[12:15], v[36:39], v[156:159]
  ds_read_b64_tr_b16 v[10:11], v1 offset:13312
  s_waitcnt lgkmcnt(6)
  v_mfma_f32_16x16x32_bf16 v[96:99], v[16:19], v[40:43], v[96:99]
  ds_read_b64_tr_b16 v[12:13], v2 offset:9216
  v_mfma_f32_16x16x32_bf16 v[100:103], v[16:19], v[44:47], v[100:103]
  ds_read_b64_tr_b16 v[14:15], v2 offset:13312
  v_mfma_f32_16x16x32_bf16 v[104:107], v[20:23], v[40:43], v[104:107]
  ds_read_b64_tr_b16 v[16:17], v3 offset:9216
  v_mfma_f32_16x16x32_bf16 v[108:111], v[20:23], v[44:47], v[108:111]
  ds_read_b64_tr_b16 v[18:19], v3 offset:13312
  s_waitcnt lgkmcnt(6)
  v_mfma_f32_16x16x32_bf16 v[112:115], v[24:27], v[40:43], v[112:115]
  ds_read_b64_tr_b16 v[20:21], v4 offset:9216
  v_mfma_f32_16x16x32_bf16 v[116:119], v[24:27], v[44:47], v[116:119]
  ds_read_b64_tr_b16 v[22:23], v4 offset:13312
  v_add_u32 v1, 0xc000, v1
  v_add_u32 v2, 0xc000, v2
  v_add_u32 v3, 0xc000, v3
  v_add_u32 v4, 0xc000, v4
  s_barrier
  v_add_u32 v7, 0x4000, v7
  v_add_u32 v5, 0x4000, v5
  ds_read_b128 v[32:35], v7 offset:0
  ds_read_b128 v[36:39], v7 offset:2048
  v_mfma_f32_16x16x32_bf16 v[120:123], v[28:31], v[40:43], v[120:123]
  ds_read_b64_tr_b16 v[24:25], v1 offset:0
  v_mfma_f32_16x16x32_bf16 v[124:127], v[28:31], v[44:47], v[124:127]
  ds_read_b64_tr_b16 v[26:27], v1 offset:4096
  s_waitcnt lgkmcnt(8)
  v_mfma_f32_16x16x32_bf16 v[128:131], v[8:11], v[40:43], v[128:131]
  ds_read_b64_tr_b16 v[28:29], v2 offset:0
  v_mfma_f32_16x16x32_bf16 v[132:135], v[8:11], v[44:47], v[132:135]
  ds_read_b64_tr_b16 v[30:31], v2 offset:4096
  v_mfma_f32_16x16x32_bf16 v[136:139], v[12:15], v[40:43], v[136:139]
  ds_read_b64_tr_b16 v[8:9], v3 offset:0
  v_mfma_f32_16x16x32_bf16 v[140:143], v[12:15], v[44:47], v[140:143]
  ds_read_b64_tr_b16 v[10:11], v3 offset:4096
  s_waitcnt lgkmcnt(8)
  v_mfma_f32_16x16x32_bf16 v[144:147], v[16:19], v[40:43], v[144:147]
  ds_read_b64_tr_b16 v[12:13], v4 offset:0
  v_mfma_f32_16x16x32_bf16 v[148:151], v[16:19], v[44:47], v[148:151]
  ds_read_b64_tr_b16 v[14:15], v4 offset:4096
  v_mfma_f32_16x16x32_bf16 v[152:155], v[20:23], v[40:43], v[152:155]
  ds_read_b64_tr_b16 v[16:17], v1 offset:1024
  v_mfma_f32_16x16x32_bf16 v[156:159], v[20:23], v[44:47], v[156:159]
  ds_read_b64_tr_b16 v[18:19], v1 offset:5120
  s_waitcnt lgkmcnt(6)
  v_mfma_f32_16x16x32_bf16 v[96:99], v[24:27], v[32:35], v[96:99]
  ds_read_b64_tr_b16 v[20:21], v2 offset:1024
  v_mfma_f32_16x16x32_bf16 v[100:103], v[24:27], v[36:39], v[100:103]
  ds_read_b64_tr_b16 v[22:23], v2 offset:5120
  v_mfma_f32_16x16x32_bf16 v[104:107], v[28:31], v[32:35], v[104:107]
  ds_read_b64_tr_b16 v[24:25], v3 offset:1024
  v_mfma_f32_16x16x32_bf16 v[108:111], v[28:31], v[36:39], v[108:111]
  ds_read_b64_tr_b16 v[26:27], v3 offset:5120
  s_waitcnt lgkmcnt(6)
  v_mfma_f32_16x16x32_bf16 v[112:115], v[8:11], v[32:35], v[112:115]
  ds_read_b64_tr_b16 v[28:29], v4 offset:1024
  v_mfma_f32_16x16x32_bf16 v[116:119], v[8:11], v[36:39], v[116:119]
  ds_read_b64_tr_b16 v[30:31], v4 offset:5120
  ds_read_b128 v[40:43], v5 offset:0
  ds_read_b128 v[44:47], v5 offset:2048
  v_mfma_f32_16x16x32_bf16 v[120:123], v[12:15], v[32:35], v[120:123]
  ds_read_b64_tr_b16 v[8:9], v1 offset:8192
  v_mfma_f32_16x16x32_bf16 v[124:127], v[12:15], v[36:39], v[124:127]
  ds_read_b64_tr_b16 v[10:11], v1 offset:12288
  s_waitcnt lgkmcnt(8)
  v_mfma_f32_16x16x32_bf16 v[128:131], v[16:19], v[32:35], v[128:131]
  ds_read_b64_tr_b16 v[12:13], v2 offset:8192
  v_mfma_f32_16x16x32_bf16 v[132:135], v[16:19], v[36:39], v[132:135]
  ds_read_b64_tr_b16 v[14:15], v2 offset:12288
  v_mfma_f32_16x16x32_bf16 v[136:139], v[20:23], v[32:35], v[136:139]
  ds_read_b64_tr_b16 v[16:17], v3 offset:8192
  v_mfma_f32_16x16x32_bf16 v[140:143], v[20:23], v[36:39], v[140:143]
  ds_read_b64_tr_b16 v[18:19], v3 offset:12288
  s_waitcnt lgkmcnt(8)
  v_mfma_f32_16x16x32_bf16 v[144:147], v[24:27], v[32:35], v[144:147]
  ds_read_b64_tr_b16 v[20:21], v4 offset:8192
  v_mfma_f32_16x16x32_bf16 v[148:151], v[24:27], v[36:39], v[148:151]
  ds_read_b64_tr_b16 v[22:23], v4 offset:12288
  v_mfma_f32_16x16x32_bf16 v[152:155], v[28:31], v[32:35], v[152:155]
  ds_read_b64_tr_b16 v[24:25], v1 offset:9216
  v_mfma_f32_16x16x32_bf16 v[156:159], v[28:31], v[36:39], v[156:159]
  ds_read_b64_tr_b16 v[26:27], v1 offset:13312
  s_waitcnt lgkmcnt(6)
  v_mfma_f32_16x16x32_bf16 v[96:99], v[8:11], v[40:43], v[96:99]
  ds_read_b64_tr_b16 v[28:29], v2 offset:9216
  v_mfma_f32_16x16x32_bf16 v[100:103], v[8:11], v[44:47], v[100:103]
  ds_read_b64_tr_b16 v[30:31], v2 offset:13312
  v_mfma_f32_16x16x32_bf16 v[104:107], v[12:15], v[40:43], v[104:107]
  ds_read_b64_tr_b16 v[8:9], v3 offset:9216
  v_mfma_f32_16x16x32_bf16 v[108:111], v[12:15], v[44:47], v[108:111]
  ds_read_b64_tr_b16 v[10:11], v3 offset:13312
  s_waitcnt lgkmcnt(6)
  v_mfma_f32_16x16x32_bf16 v[112:115], v[16:19], v[40:43], v[112:115]
  ds_read_b64_tr_b16 v[12:13], v4 offset:9216
  v_mfma_f32_16x16x32_bf16 v[116:119], v[16:19], v[44:47], v[116:119]
  ds_read_b64_tr_b16 v[14:15], v4 offset:13312
  v_add_u32 v1, 0xffffc000, v1
  v_add_u32 v2, 0xffffc000, v2
  v_add_u32 v3, 0xffffc000, v3
  v_add_u32 v4, 0xffffc000, v4
  s_barrier
  v_add_u32 v7, 0x4000, v7
  v_add_u32 v5, 0x4000, v5
  ds_read_b128 v[32:35], v7 offset:0
  ds_read_b128 v[36:39], v7 offset:2048
  v_mfma_f32_16x16x32_bf16 v[120:123], v[20:23], v[40:43], v[120:123]
  ds_read_b64_tr_b16 v[16:17], v1 offset:0
  v_mfma_f32_16x16x32_bf16 v[124:127], v[20:23], v[44:47], v[124:127]
  ds_read_b64_tr_b16 v[18:19], v1 offset:4096
  s_waitcnt lgkmcnt(8)
  v_mfma_f32_16x16x32_bf16 v[128:131], v[24:27], v[40:43], v[128:131]
  ds_read_b64_tr_b16 v[20:21], v2 offset:0
  v_mfma_f32_16x16x32_bf16 v[132:135], v[24:27], v[44:47], v[132:135]
  ds_read_b64_tr_b16 v[22:23], v2 offset:4096
  v_mfma_f32_16x16x32_bf16 v[136:139], v[28:31], v[40:43], v[136:139]
  ds_read_b64_tr_b16 v[24:25], v3 offset:0
  v_mfma_f32_16x16x32_bf16 v[140:143], v[28:31], v[44:47], v[140:143]
  ds_read_b64_tr_b16 v[26:27], v3 offset:4096
  s_waitcnt lgkmcnt(8)
  v_mfma_f32_16x16x32_bf16 v[144:147], v[8:11], v[40:43], v[144:147]
  ds_read_b64_tr_b16 v[28:29], v4 offset:0
  v_mfma_f32_16x16x32_bf16 v[148:151], v[8:11], v[44:47], v[148:151]
  ds_read_b64_tr_b16 v[30:31], v4 offset:4096
  v_mfma_f32_16x16x32_bf16 v[152:155], v[12:15], v[40:43], v[152:155]
  ds_read_b64_tr_b16 v[8:9], v1 offset:1024
  v_mfma_f32_16x16x32_bf16 v[156:159], v[12:15], v[44:47], v[156:159]
  ds_read_b64_tr_b16 v[10:11], v1 offset:5120
  s_waitcnt lgkmcnt(6)
  v_mfma_f32_16x16x32_bf16 v[96:99], v[16:19], v[32:35], v[96:99]
  ds_read_b64_tr_b16 v[12:13], v2 offset:1024
  v_mfma_f32_16x16x32_bf16 v[100:103], v[16:19], v[36:39], v[100:103]
  ds_read_b64_tr_b16 v[14:15], v2 offset:5120
  v_mfma_f32_16x16x32_bf16 v[104:107], v[20:23], v[32:35], v[104:107]
  ds_read_b64_tr_b16 v[16:17], v3 offset:1024
  v_mfma_f32_16x16x32_bf16 v[108:111], v[20:23], v[36:39], v[108:111]
  ds_read_b64_tr_b16 v[18:19], v3 offset:5120
  s_waitcnt lgkmcnt(6)
  v_mfma_f32_16x16x32_bf16 v[112:115], v[24:27], v[32:35], v[112:115]
  ds_read_b64_tr_b16 v[20:21], v4 offset:1024
  v_mfma_f32_16x16x32_bf16 v[116:119], v[24:27], v[36:39], v[116:119]
  ds_read_b64_tr_b16 v[22:23], v4 offset:5120
  ds_read_b128 v[40:43], v5 offset:0
  ds_read_b128 v[44:47], v5 offset:2048
  v_mfma_f32_16x16x32_bf16 v[120:123], v[28:31], v[32:35], v[120:123]
  ds_read_b64_tr_b16 v[24:25], v1 offset:8192
  v_mfma_f32_16x16x32_bf16 v[124:127], v[28:31], v[36:39], v[124:127]
  ds_read_b64_tr_b16 v[26:27], v1 offset:12288
  s_waitcnt lgkmcnt(8)
  v_mfma_f32_16x16x32_bf16 v[128:131], v[8:11], v[32:35], v[128:131]
  ds_read_b64_tr_b16 v[28:29], v2 offset:8192
  v_mfma_f32_16x16x32_bf16 v[132:135], v[8:11], v[36:39], v[132:135]
  ds_read_b64_tr_b16 v[30:31], v2 offset:12288
  v_mfma_f32_16x16x32_bf16 v[136:139], v[12:15], v[32:35], v[136:139]
  ds_read_b64_tr_b16 v[8:9], v3 offset:8192
  v_mfma_f32_16x16x32_bf16 v[140:143], v[12:15], v[36:39], v[140:143]
  ds_read_b64_tr_b16 v[10:11], v3 offset:12288
  s_waitcnt lgkmcnt(8)
  v_mfma_f32_16x16x32_bf16 v[144:147], v[16:19], v[32:35], v[144:147]
  ds_read_b64_tr_b16 v[12:13], v4 offset:8192
  v_mfma_f32_16x16x32_bf16 v[148:151], v[16:19], v[36:39], v[148:151]
  ds_read_b64_tr_b16 v[14:15], v4 offset:12288
  v_mfma_f32_16x16x32_bf16 v[152:155], v[20:23], v[32:35], v[152:155]
  ds_read_b64_tr_b16 v[16:17], v1 offset:9216
  v_mfma_f32_16x16x32_bf16 v[156:159], v[20:23], v[36:39], v[156:159]
  ds_read_b64_tr_b16 v[18:19], v1 offset:13312
  s_waitcnt lgkmcnt(6)
  v_mfma_f32_16x16x32_bf16 v[96:99], v[24:27], v[40:43], v[96:99]
  ds_read_b64_tr_b16 v[20:21], v2 offset:9216
  v_mfma_f32_16x16x32_bf16 v[100:103], v[24:27], v[44:47], v[100:103]
  ds_read_b64_tr_b16 v[22:23], v2 offset:13312
  v_mfma_f32_16x16x32_bf16 v[104:107], v[28:31], v[40:43], v[104:107]
  ds_read_b64_tr_b16 v[24:25], v3 offset:9216
  v_mfma_f32_16x16x32_bf16 v[108:111], v[28:31], v[44:47], v[108:111]
  ds_read_b64_tr_b16 v[26:27], v3 offset:13312
  s_waitcnt lgkmcnt(6)
  v_mfma_f32_16x16x32_bf16 v[112:115], v[8:11], v[40:43], v[112:115]
  ds_read_b64_tr_b16 v[28:29], v4 offset:9216
  v_mfma_f32_16x16x32_bf16 v[116:119], v[8:11], v[44:47], v[116:119]
  ds_read_b64_tr_b16 v[30:31], v4 offset:13312
  v_add_u32 v1, 0xffffc000, v1
  v_add_u32 v2, 0xffffc000, v2
  v_add_u32 v3, 0xffffc000, v3
  v_add_u32 v4, 0xffffc000, v4
  s_barrier
  v_add_u32 v7, 0x4000, v7
  v_add_u32 v5, 0x4000, v5
  ds_read_b128 v[32:35], v7 offset:0
  ds_read_b128 v[36:39], v7 offset:2048
  v_mfma_f32_16x16x32_bf16 v[120:123], v[12:15], v[40:43], v[120:123]
  ds_read_b64_tr_b16 v[8:9], v1 offset:0
  v_mfma_f32_16x16x32_bf16 v[124:127], v[12:15], v[44:47], v[124:127]
  ds_read_b64_tr_b16 v[10:11], v1 offset:4096
  s_waitcnt lgkmcnt(8)
  v_mfma_f32_16x16x32_bf16 v[128:131], v[16:19], v[40:43], v[128:131]
  ds_read_b64_tr_b16 v[12:13], v2 offset:0
  v_mfma_f32_16x16x32_bf16 v[132:135], v[16:19], v[44:47], v[132:135]
  ds_read_b64_tr_b16 v[14:15], v2 offset:4096
  v_mfma_f32_16x16x32_bf16 v[136:139], v[20:23], v[40:43], v[136:139]
  ds_read_b64_tr_b16 v[16:17], v3 offset:0
  v_mfma_f32_16x16x32_bf16 v[140:143], v[20:23], v[44:47], v[140:143]
  ds_read_b64_tr_b16 v[18:19], v3 offset:4096
  s_waitcnt lgkmcnt(8)
  v_mfma_f32_16x16x32_bf16 v[144:147], v[24:27], v[40:43], v[144:147]
  ds_read_b64_tr_b16 v[20:21], v4 offset:0
  v_mfma_f32_16x16x32_bf16 v[148:151], v[24:27], v[44:47], v[148:151]
  ds_read_b64_tr_b16 v[22:23], v4 offset:4096
  v_mfma_f32_16x16x32_bf16 v[152:155], v[28:31], v[40:43], v[152:155]
  ds_read_b64_tr_b16 v[24:25], v1 offset:1024
  v_mfma_f32_16x16x32_bf16 v[156:159], v[28:31], v[44:47], v[156:159]
  ds_read_b64_tr_b16 v[26:27], v1 offset:5120
  s_waitcnt lgkmcnt(6)
  v_mfma_f32_16x16x32_bf16 v[96:99], v[8:11], v[32:35], v[96:99]
  ds_read_b64_tr_b16 v[28:29], v2 offset:1024
  v_mfma_f32_16x16x32_bf16 v[100:103], v[8:11], v[36:39], v[100:103]
  ds_read_b64_tr_b16 v[30:31], v2 offset:5120
  v_mfma_f32_16x16x32_bf16 v[104:107], v[12:15], v[32:35], v[104:107]
  ds_read_b64_tr_b16 v[8:9], v3 offset:1024
  v_mfma_f32_16x16x32_bf16 v[108:111], v[12:15], v[36:39], v[108:111]
  ds_read_b64_tr_b16 v[10:11], v3 offset:5120
  s_waitcnt lgkmcnt(6)
  v_mfma_f32_16x16x32_bf16 v[112:115], v[16:19], v[32:35], v[112:115]
  ds_read_b64_tr_b16 v[12:13], v4 offset:1024
  v_mfma_f32_16x16x32_bf16 v[116:119], v[16:19], v[36:39], v[116:119]
  ds_read_b64_tr_b16 v[14:15], v4 offset:5120
  ds_read_b128 v[40:43], v5 offset:0
  ds_read_b128 v[44:47], v5 offset:2048
  v_mfma_f32_16x16x32_bf16 v[120:123], v[20:23], v[32:35], v[120:123]
  ds_read_b64_tr_b16 v[16:17], v1 offset:8192
  v_mfma_f32_16x16x32_bf16 v[124:127], v[20:23], v[36:39], v[124:127]
  ds_read_b64_tr_b16 v[18:19], v1 offset:12288
  s_waitcnt lgkmcnt(8)
  v_mfma_f32_16x16x32_bf16 v[128:131], v[24:27], v[32:35], v[128:131]
  ds_read_b64_tr_b16 v[20:21], v2 offset:8192
  v_mfma_f32_16x16x32_bf16 v[132:135], v[24:27], v[36:39], v[132:135]
  ds_read_b64_tr_b16 v[22:23], v2 offset:12288
  v_mfma_f32_16x16x32_bf16 v[136:139], v[28:31], v[32:35], v[136:139]
  ds_read_b64_tr_b16 v[24:25], v3 offset:8192
  v_mfma_f32_16x16x32_bf16 v[140:143], v[28:31], v[36:39], v[140:143]
  ds_read_b64_tr_b16 v[26:27], v3 offset:12288
  s_waitcnt lgkmcnt(8)
  v_mfma_f32_16x16x32_bf16 v[144:147], v[8:11], v[32:35], v[144:147]
  ds_read_b64_tr_b16 v[28:29], v4 offset:8192
  v_mfma_f32_16x16x32_bf16 v[148:151], v[8:11], v[36:39], v[148:151]
  ds_read_b64_tr_b16 v[30:31], v4 offset:12288
  v_mfma_f32_16x16x32_bf16 v[152:155], v[12:15], v[32:35], v[152:155]
  ds_read_b64_tr_b16 v[8:9], v1 offset:9216
  v_mfma_f32_16x16x32_bf16 v[156:159], v[12:15], v[36:39], v[156:159]
  ds_read_b64_tr_b16 v[10:11], v1 offset:13312
  s_waitcnt lgkmcnt(6)
  v_mfma_f32_16x16x32_bf16 v[96:99], v[16:19], v[40:43], v[96:99]
  ds_read_b64_tr_b16 v[12:13], v2 offset:9216
  v_mfma_f32_16x16x32_bf16 v[100:103], v[16:19], v[44:47], v[100:103]
  ds_read_b64_tr_b16 v[14:15], v2 offset:13312
  v_mfma_f32_16x16x32_bf16 v[104:107], v[20:23], v[40:43], v[104:107]
  ds_read_b64_tr_b16 v[16:17], v3 offset:9216
  v_mfma_f32_16x16x32_bf16 v[108:111], v[20:23], v[44:47], v[108:111]
  ds_read_b64_tr_b16 v[18:19], v3 offset:13312
  s_waitcnt lgkmcnt(6)
  v_mfma_f32_16x16x32_bf16 v[112:115], v[24:27], v[40:43], v[112:115]
  ds_read_b64_tr_b16 v[20:21], v4 offset:9216
  v_mfma_f32_16x16x32_bf16 v[116:119], v[24:27], v[44:47], v[116:119]
  ds_read_b64_tr_b16 v[22:23], v4 offset:13312
  v_add_u32 v1, 0xffffc000, v1
  v_add_u32 v2, 0xffffc000, v2
  v_add_u32 v3, 0xffffc000, v3
  v_add_u32 v4, 0xffffc000, v4
  s_barrier
  v_add_u32 v7, 0x4000, v7
  v_add_u32 v5, 0x4000, v5
  ds_read_b128 v[32:35], v7 offset:0
  ds_read_b128 v[36:39], v7 offset:2048
  v_mfma_f32_16x16x32_bf16 v[120:123], v[28:31], v[40:43], v[120:123]
  ds_read_b64_tr_b16 v[24:25], v1 offset:0
  v_mfma_f32_16x16x32_bf16 v[124:127], v[28:31], v[44:47], v[124:127]
  ds_read_b64_tr_b16 v[26:27], v1 offset:4096
  s_waitcnt lgkmcnt(8)
  v_mfma_f32_16x16x32_bf16 v[128:131], v[8:11], v[40:43], v[128:131]
  ds_read_b64_tr_b16 v[28:29], v2 offset:0
  v_mfma_f32_16x16x32_bf16 v[132:135], v[8:11], v[44:47], v[132:135]
  ds_read_b64_tr_b16 v[30:31], v2 offset:4096
  v_mfma_f32_16x16x32_bf16 v[136:139], v[12:15], v[40:43], v[136:139]
  ds_read_b64_tr_b16 v[8:9], v3 offset:0
  v_mfma_f32_16x16x32_bf16 v[140:143], v[12:15], v[44:47], v[140:143]
  ds_read_b64_tr_b16 v[10:11], v3 offset:4096
  s_waitcnt lgkmcnt(8)
  v_mfma_f32_16x16x32_bf16 v[144:147], v[16:19], v[40:43], v[144:147]
  ds_read_b64_tr_b16 v[12:13], v4 offset:0
  v_mfma_f32_16x16x32_bf16 v[148:151], v[16:19], v[44:47], v[148:151]
  ds_read_b64_tr_b16 v[14:15], v4 offset:4096
  v_mfma_f32_16x16x32_bf16 v[152:155], v[20:23], v[40:43], v[152:155]
  ds_read_b64_tr_b16 v[16:17], v1 offset:1024
  v_mfma_f32_16x16x32_bf16 v[156:159], v[20:23], v[44:47], v[156:159]
  ds_read_b64_tr_b16 v[18:19], v1 offset:5120
  s_waitcnt lgkmcnt(6)
  v_mfma_f32_16x16x32_bf16 v[96:99], v[24:27], v[32:35], v[96:99]
  ds_read_b64_tr_b16 v[20:21], v2 offset:1024
  v_mfma_f32_16x16x32_bf16 v[100:103], v[24:27], v[36:39], v[100:103]
  ds_read_b64_tr_b16 v[22:23], v2 offset:5120
  v_mfma_f32_16x16x32_bf16 v[104:107], v[28:31], v[32:35], v[104:107]
  ds_read_b64_tr_b16 v[24:25], v3 offset:1024
  v_mfma_f32_16x16x32_bf16 v[108:111], v[28:31], v[36:39], v[108:111]
  ds_read_b64_tr_b16 v[26:27], v3 offset:5120
  s_waitcnt lgkmcnt(6)
  v_mfma_f32_16x16x32_bf16 v[112:115], v[8:11], v[32:35], v[112:115]
  ds_read_b64_tr_b16 v[28:29], v4 offset:1024
  v_mfma_f32_16x16x32_bf16 v[116:119], v[8:11], v[36:39], v[116:119]
  ds_read_b64_tr_b16 v[30:31], v4 offset:5120
  ds_read_b128 v[40:43], v5 offset:0
  ds_read_b128 v[44:47], v5 offset:2048
  v_mfma_f32_16x16x32_bf16 v[120:123], v[12:15], v[32:35], v[120:123]
  ds_read_b64_tr_b16 v[8:9], v1 offset:8192
  v_mfma_f32_16x16x32_bf16 v[124:127], v[12:15], v[36:39], v[124:127]
  ds_read_b64_tr_b16 v[10:11], v1 offset:12288
  s_waitcnt lgkmcnt(8)
  v_mfma_f32_16x16x32_bf16 v[128:131], v[16:19], v[32:35], v[128:131]
  ds_read_b64_tr_b16 v[12:13], v2 offset:8192
  v_mfma_f32_16x16x32_bf16 v[132:135], v[16:19], v[36:39], v[132:135]
  ds_read_b64_tr_b16 v[14:15], v2 offset:12288
  v_mfma_f32_16x16x32_bf16 v[136:139], v[20:23], v[32:35], v[136:139]
  ds_read_b64_tr_b16 v[16:17], v3 offset:8192
  v_mfma_f32_16x16x32_bf16 v[140:143], v[20:23], v[36:39], v[140:143]
  ds_read_b64_tr_b16 v[18:19], v3 offset:12288
  s_waitcnt lgkmcnt(8)
  v_mfma_f32_16x16x32_bf16 v[144:147], v[24:27], v[32:35], v[144:147]
  ds_read_b64_tr_b16 v[20:21], v4 offset:8192
  v_mfma_f32_16x16x32_bf16 v[148:151], v[24:27], v[36:39], v[148:151]
  ds_read_b64_tr_b16 v[22:23], v4 offset:12288
  v_mfma_f32_16x16x32_bf16 v[152:155], v[28:31], v[32:35], v[152:155]
  ds_read_b64_tr_b16 v[24:25], v1 offset:9216
  v_mfma_f32_16x16x32_bf16 v[156:159], v[28:31], v[36:39], v[156:159]
  ds_read_b64_tr_b16 v[26:27], v1 offset:13312
  s_waitcnt lgkmcnt(6)
  v_mfma_f32_16x16x32_bf16 v[96:99], v[8:11], v[40:43], v[96:99]
  ds_read_b64_tr_b16 v[28:29], v2 offset:9216
  v_mfma_f32_16x16x32_bf16 v[100:103], v[8:11], v[44:47], v[100:103]
  ds_read_b64_tr_b16 v[30:31], v2 offset:13312
  v_mfma_f32_16x16x32_bf16 v[104:107], v[12:15], v[40:43], v[104:107]
  ds_read_b64_tr_b16 v[8:9], v3 offset:9216
  v_mfma_f32_16x16x32_bf16 v[108:111], v[12:15], v[44:47], v[108:111]
  ds_read_b64_tr_b16 v[10:11], v3 offset:13312
  s_waitcnt lgkmcnt(6)
  v_mfma_f32_16x16x32_bf16 v[112:115], v[16:19], v[40:43], v[112:115]
  ds_read_b64_tr_b16 v[12:13], v4 offset:9216
  v_mfma_f32_16x16x32_bf16 v[116:119], v[16:19], v[44:47], v[116:119]
  ds_read_b64_tr_b16 v[14:15], v4 offset:13312
  v_mfma_f32_16x16x32_bf16 v[120:123], v[20:23], v[40:43], v[120:123]
  v_mfma_f32_16x16x32_bf16 v[124:127], v[20:23], v[44:47], v[124:127]
  s_waitcnt lgkmcnt(4)
  v_mfma_f32_16x16x32_bf16 v[128:131], v[24:27], v[40:43], v[128:131]
  v_mfma_f32_16x16x32_bf16 v[132:135], v[24:27], v[44:47], v[132:135]
  v_mfma_f32_16x16x32_bf16 v[136:139], v[28:31], v[40:43], v[136:139]
  v_mfma_f32_16x16x32_bf16 v[140:143], v[28:31], v[44:47], v[140:143]
  s_waitcnt lgkmcnt(0)
  v_mfma_f32_16x16x32_bf16 v[144:147], v[8:11], v[40:43], v[144:147]
  v_mfma_f32_16x16x32_bf16 v[148:151], v[8:11], v[44:47], v[148:151]
  v_mfma_f32_16x16x32_bf16 v[152:155], v[12:15], v[40:43], v[152:155]
  v_mfma_f32_16x16x32_bf16 v[156:159], v[12:15], v[44:47], v[156:159]
  s_waitcnt vmcnt(0)
  v_mov_b32 v8, 161792
  v_mov_b32 v9, 1
  s_mov_b64 exec, 1
  ds_add_u32 v8, v9 offset:28
  s_mov_b64 exec, -1
  v_mov_b32 v8, 161792
  s_mov_b32 s63, 0x400000
LW_19:
  ds_read_b32 v9, v8 offset:20
  s_sub_u32 s63, s63, 1
  s_waitcnt lgkmcnt(0)
  v_readfirstlane_b32 s62, v9
  s_cmp_eq_u32 s63, 0
  s_cbranch_scc1 LWOK_20
  s_cmp_ge_u32 s62, 1
  s_cbranch_scc1 LWOK_20
  s_sleep 1
  s_branch LW_19
LWOK_20:
  v_and_b32 v16, 15, v0
  v_lshrrev_b32 v17, 4, v0
  s_lshl_b32 s3, s19, 9
  s_add_u32 s3, s3, 158720
  v_lshl_add_u32 v8, v16, 4, s3
  v_lshlrev_b32 v164, 4, v17
  v_add_u32 v164, 160768, v164
  v_mov_b32 v10, 161792
  ds_read_b64 v[160:161], v8 offset:0
  ds_read_b64 v[162:163], v8 offset:256
  ds_read_b32 v10, v10
  ds_read_b128 v[24:27], v164 offset:0
  v_lshlrev_b32 v166, 4, v0
  s_lshl_b32 s52, s20, 2
  s_add_u32 s52, s52, s19
  s_lshl_b32 s53, s23, 8
  s_add_u32 s53, s53, s52
  s_lshl_b32 s53, s53, 10
  s_mul_i32 s54, s52, 112
  s_mul_i32 s55, s23, 3
  s_add_u32 s55, s55, s54
  s_add_u32 s55, s55, 64
  s_lshl_b32 s55, s55, 10
  s_lshl_b32 s3, s22, 2
  s_add_u32 s54, s54, s3
  s_lshl_b32 s54, s54, 10
  s_add_u32 s54, s54, 0x600000
  s_add_u32 s55, s55, 0x600000
  s_waitcnt lgkmcnt(1)
  v_readfirstlane_b32 s61, v10
  s_waitcnt lgkmcnt(0)
  ds_read_b128 v[28:31], v164 offset:64
  v_mul_f32 v8, v24, v161
  v_mul_f32 v9, v25, v161
  v_mul_f32 v10, v26, v161
  v_mul_f32 v11, v27, v161
  v_mul_f32 v12, v24, v163
  v_mul_f32 v13, v25, v163
  v_mul_f32 v14, v26, v163
  v_mul_f32 v15, v27, v163
  v_fmac_f32 v8, v96, v160
  v_fmac_f32 v9, v97, v160
  v_fmac_f32 v10, v98, v160
  v_fmac_f32 v11, v99, v160
  v_fmac_f32 v12, v100, v162
  v_fmac_f32 v13, v101, v162
  v_fmac_f32 v14, v102, v162
  v_fmac_f32 v15, v103, v162
  v_cvt_pk_bf16_f32 v16, v8, v9
  v_cvt_pk_bf16_f32 v17, v10, v11
  v_cvt_pk_bf16_f32 v18, v12, v13
  v_cvt_pk_bf16_f32 v19, v14, v15
  s_nop 2
  v_permlane16_swap_b32 v16, v18
  v_permlane16_swap_b32 v17, v19
  s_add_u32 s3, s53, 0x0
  s_nop 0
  buffer_store_dwordx4 v[16:19], v166, s[40:43], s3 offen sc1
  s_waitcnt lgkmcnt(0)
  ds_read_b128 v[24:27], v164 offset:128
  v_mul_f32 v8, v28, v161
  v_mul_f32 v9, v29, v161
  v_mul_f32 v10, v30, v161
  v_mul_f32 v11, v31, v161
  v_mul_f32 v12, v28, v163
  v_mul_f32 v13, v29, v163
  v_mul_f32 v14, v30, v163
  v_mul_f32 v15, v31, v163
  v_fmac_f32 v8, v104, v160
  v_fmac_f32 v9, v105, v160
  v_fmac_f32 v10, v106, v160
  v_fmac_f32 v11, v107, v160
  v_fmac_f32 v12, v108, v162
  v_fmac_f32 v13, v109, v162
  v_fmac_f32 v14, v110, v162
  v_fmac_f32 v15, v111, v162
  v_cvt_pk_bf16_f32 v20, v8, v9
  v_cvt_pk_bf16_f32 v21, v10, v11
  v_cvt_pk_bf16_f32 v22, v12, v13
  v_cvt_pk_bf16_f32 v23, v14, v15
  s_nop 2
  v_permlane16_swap_b32 v20, v22
  v_permlane16_swap_b32 v21, v23
  s_add_u32 s3, s53, 0x10000
  s_nop 0
  buffer_store_dwordx4 v[20:23], v166, s[40:43], s3 offen sc1
  s_waitcnt lgkmcnt(0)
  ds_read_b128 v[28:31], v164 offset:192
  v_mul_f32 v8, v24, v161
  v_mul_f32 v9, v25, v161
  v_mul_f32 v10, v26, v161
  v_mul_f32 v11, v27, v161
  v_mul_f32 v12, v24, v163
  v_mul_f32 v13, v25, v163
  v_mul_f32 v14, v26, v163
  v_mul_f32 v15, v27, v163
  v_fmac_f32 v8, v112, v160
  v_fmac_f32 v9, v113, v160
  v_fmac_f32 v10, v114, v160
  v_fmac_f32 v11, v115, v160
  v_fmac_f32 v12, v116, v162
  v_fmac_f32 v13, v117, v162
  v_fmac_f32 v14, v118, v162
  v_fmac_f32 v15, v119, v162
  v_cvt_pk_bf16_f32 v16, v8, v9
  v_cvt_pk_bf16_f32 v17, v10, v11
  v_cvt_pk_bf16_f32 v18, v12, v13
  v_cvt_pk_bf16_f32 v19, v14, v15
  s_nop 2
  v_permlane16_swap_b32 v16, v18
  v_permlane16_swap_b32 v17, v19
  s_add_u32 s3, s53, 0x20000
  s_nop 0
  buffer_store_dwordx4 v[16:19], v166, s[40:43], s3 offen sc1
  s_waitcnt lgkmcnt(0)
  ds_read_b128 v[24:27], v164 offset:320
  v_mul_f32 v8, v28, v161
  v_mul_f32 v9, v29, v161
  v_mul_f32 v10, v30, v161
  v_mul_f32 v11, v31, v161
  v_mul_f32 v12, v28, v163
  v_mul_f32 v13, v29, v163
  v_mul_f32 v14, v30, v163
  v_mul_f32 v15, v31, v163
  v_fmac_f32 v8, v120, v160
  v_fmac_f32 v9, v121, v160
  v_fmac_f32 v10, v122, v160
  v_fmac_f32 v11, v123, v160
  v_fmac_f32 v12, v124, v162
  v_fmac_f32 v13, v125, v162
  v_fmac_f32 v14, v126, v162
  v_fmac_f32 v15, v127, v162
  v_cvt_pk_bf16_f32 v20, v8, v9
  v_cvt_pk_bf16_f32 v21, v10, v11
  v_cvt_pk_bf16_f32 v22, v12, v13
  v_cvt_pk_bf16_f32 v23, v14, v15
  s_nop 2
  v_permlane16_swap_b32 v20, v22
  v_permlane16_swap_b32 v21, v23
  s_add_u32 s3, s53, 0x30000
  s_nop 0
  buffer_store_dwordx4 v[20:23], v166, s[40:43], s3 offen sc1
  s_waitcnt lgkmcnt(0)
  ds_read_b128 v[28:31], v164 offset:384
  v_mul_f32 v8, v24, v161
  v_mul_f32 v9, v25, v161
  v_mul_f32 v10, v26, v161
  v_mul_f32 v11, v27, v161
  v_mul_f32 v12, v24, v163
  v_mul_f32 v13, v25, v163
  v_mul_f32 v14, v26, v163
  v_mul_f32 v15, v27, v163
  v_fmac_f32 v8, v136, v160
  v_fmac_f32 v9, v137, v160
  v_fmac_f32 v10, v138, v160
  v_fmac_f32 v11, v139, v160
  v_fmac_f32 v12, v140, v162
  v_fmac_f32 v13, v141, v162
  v_fmac_f32 v14, v142, v162
  v_fmac_f32 v15, v143, v162
  v_cvt_pk_bf16_f32 v136, v8, v9
  v_cvt_pk_bf16_f32 v137, v10, v11
  v_cvt_pk_bf16_f32 v138, v12, v13
  v_cvt_pk_bf16_f32 v139, v14, v15
  s_nop 2
  v_permlane16_swap_b32 v136, v138
  v_permlane16_swap_b32 v137, v139
  s_nop 0
  s_nop 0
  v_pk_max_i16 v136, v136, 0
  v_pk_max_i16 v138, v138, 0
  v_pk_max_i16 v137, v137, 0
  v_pk_max_i16 v139, v139, 0
  s_waitcnt lgkmcnt(0)
  ds_read_b128 v[24:27], v164 offset:448
  v_mul_f32 v8, v28, v161
  v_mul_f32 v9, v29, v161
  v_mul_f32 v10, v30, v161
  v_mul_f32 v11, v31, v161
  v_mul_f32 v12, v28, v163
  v_mul_f32 v13, v29, v163
  v_mul_f32 v14, v30, v163
  v_mul_f32 v15, v31, v163
  v_fmac_f32 v8, v144, v160
  v_fmac_f32 v9, v145, v160
  v_fmac_f32 v10, v146, v160
  v_fmac_f32 v11, v147, v160
  v_fmac_f32 v12, v148, v162
  v_fmac_f32 v13, v149, v162
  v_fmac_f32 v14, v150, v162
  v_fmac_f32 v15, v151, v162
  v_cvt_pk_bf16_f32 v144, v8, v9
  v_cvt_pk_bf16_f32 v145, v10, v11
  v_cvt_pk_bf16_f32 v146, v12, v13
  v_cvt_pk_bf16_f32 v147, v14, v15
  s_nop 2
  v_permlane16_swap_b32 v144, v146
  v_permlane16_swap_b32 v145, v147
  s_nop 0
  s_nop 0
  v_pk_max_i16 v144, v144, 0
  v_pk_max_i16 v146, v146, 0
  v_pk_max_i16 v145, v145, 0
  v_pk_max_i16 v147, v147, 0
  s_waitcnt lgkmcnt(0)
  ds_read_b128 v[28:31], v164 offset:256
  v_mul_f32 v8, v24, v161
  v_mul_f32 v9, v25, v161
  v_mul_f32 v10, v26, v161
  v_mul_f32 v11, v27, v161
  v_mul_f32 v12, v24, v163
  v_mul_f32 v13, v25, v163
  v_mul_f32 v14, v26, v163
  v_mul_f32 v15, v27, v163
  v_fmac_f32 v8, v152, v160
  v_fmac_f32 v9, v153, v160
  v_fmac_f32 v10, v154, v160
  v_fmac_f32 v11, v155, v160
  v_fmac_f32 v12, v156, v162
  v_fmac_f32 v13, v157, v162
  v_fmac_f32 v14, v158, v162
  v_fmac_f32 v15, v159, v162
  v_cvt_pk_bf16_f32 v152, v8, v9
  v_cvt_pk_bf16_f32 v153, v10, v11
  v_cvt_pk_bf16_f32 v154, v12, v13
  v_cvt_pk_bf16_f32 v155, v14, v15
  s_nop 2
  v_permlane16_swap_b32 v152, v154
  v_permlane16_swap_b32 v153, v155
  s_nop 0
  s_nop 0
  v_pk_max_i16 v152, v152, 0
  v_pk_max_i16 v154, v154, 0
  v_pk_max_i16 v153, v153, 0
  v_pk_max_i16 v155, v155, 0
  s_waitcnt lgkmcnt(0)
  v_mul_f32 v8, v28, v161
  v_mul_f32 v9, v29, v161
  v_mul_f32 v10, v30, v161
  v_mul_f32 v11, v31, v161
  v_mul_f32 v12, v28, v163
  v_mul_f32 v13, v29, v163
  v_mul_f32 v14, v30, v163
  v_mul_f32 v15, v31, v163
  v_fmac_f32 v8, v128, v160
  v_fmac_f32 v9, v129, v160
  v_fmac_f32 v10, v130, v160
  v_fmac_f32 v11, v131, v160
  v_fmac_f32 v12, v132, v162
  v_fmac_f32 v13, v133, v162
  v_fmac_f32 v14, v134, v162
  v_fmac_f32 v15, v135, v162
  v_cvt_pk_bf16_f32 v156, v8, v9
  v_cvt_pk_bf16_f32 v157, v10, v11
  v_cvt_pk_bf16_f32 v158, v12, v13
  v_cvt_pk_bf16_f32 v159, v14, v15
  s_nop 2
  v_permlane16_swap_b32 v156, v158
  v_permlane16_swap_b32 v157, v159
  s_nop 0
  s_nop 0
  v_pk_max_i16 v156, v156, 0
  v_pk_max_i16 v158, v158, 0
  v_pk_max_i16 v157, v157, 0
  v_pk_max_i16 v159, v159, 0
  v_lshrrev_b32 v8, 2, v0
  v_and_b32 v10, 3, v0
  v_lshlrev_b32 v10, 3, v10
  v_lshl_add_u32 v1, v8, 6, v10
  v_bfe_u32 v11, v0, 4, 1
  v_lshl_add_u32 v1, v11, 5, v1
  v_add_u32 v1, 147456, v1
  v_xor_b32 v2, 32, v1
  v_mul_u32_u24 v3, 96, v8
  v_add_u32 v3, v3, v10
  v_add_u32 v3, 147456, v3
  s_waitcnt lgkmcnt(0)
  s_barrier
  s_add_u32 s3, s54, 0
  buffer_store_dwordx4 v[156:159], v166, s[40:43], s3 offen sc1
  s_add_u32 s3, s54, 1024
  buffer_store_dwordx4 v[136:139], v166, s[40:43], s3 offen sc1
  s_add_u32 s3, s54, 2048
  buffer_store_dwordx4 v[144:147], v166, s[40:43], s3 offen sc1
  s_add_u32 s3, s54, 3072
  buffer_store_dwordx4 v[152:155], v166, s[40:43], s3 offen sc1
  s_waitcnt vmcnt(4)
  s_mov_b64 exec, 1
  ds_add_rtn_u32 v164, v6, v165 offset:4
  s_mov_b64 exec, -1
  v_add_u32 v7, 0xffff0000, v7
  v_add_u32 v5, 0xffff0000, v5
  ds_read_b128 v[32:35], v7 offset:0
  ds_read_b128 v[36:39], v7 offset:2048
  ds_read_b64_tr_b16 v[8:9], v1 offset:0
  ds_read_b64_tr_b16 v[10:11], v1 offset:1024
  ds_read_b64_tr_b16 v[12:13], v2 offset:0
  ds_read_b64_tr_b16 v[14:15], v2 offset:1024
  ds_read_b64_tr_b16 v[16:17], v3 offset:2048
  ds_read_b64_tr_b16 v[18:19], v3 offset:3584
  ds_read_b64_tr_b16 v[20:21], v3 offset:2080
  ds_read_b64_tr_b16 v[22:23], v3 offset:3616
  ds_read_b64_tr_b16 v[24:25], v3 offset:2112
  ds_read_b64_tr_b16 v[26:27], v3 offset:3648
  ds_read_b128 v[40:43], v5 offset:0
  ds_read_b128 v[44:47], v5 offset:2048
  s_waitcnt lgkmcnt(8)
  v_mfma_f32_16x16x32_bf16 v[96:99], v[8:11], v[32:35], 0
  ds_read_b64_tr_b16 v[28:29], v1 offset:5120
  v_mfma_f32_16x16x32_bf16 v[100:103], v[8:11], v[36:39], 0
  ds_read_b64_tr_b16 v[30:31], v1 offset:6144
  v_mfma_f32_16x16x32_bf16 v[104:107], v[12:15], v[32:35], 0
  ds_read_b64_tr_b16 v[8:9], v2 offset:5120
  v_mfma_f32_16x16x32_bf16 v[108:111], v[12:15], v[36:39], 0
  ds_read_b64_tr_b16 v[10:11], v2 offset:6144
  s_waitcnt lgkmcnt(8)
  v_mfma_f32_16x16x32_bf16 v[112:115], v[16:19], v[32:35], 0
  ds_read_b64_tr_b16 v[12:13], v3 offset:7168
  v_mfma_f32_16x16x32_bf16 v[116:119], v[16:19], v[36:39], 0
  ds_read_b64_tr_b16 v[14:15], v3 offset:8704
  v_mfma_f32_16x16x32_bf16 v[120:123], v[20:23], v[32:35], 0
  ds_read_b64_tr_b16 v[16:17], v3 offset:7200
  v_mfma_f32_16x16x32_bf16 v[124:127], v[20:23], v[36:39], 0
  ds_read_b64_tr_b16 v[18:19], v3 offset:8736
  s_waitcnt lgkmcnt(6)
  v_mfma_f32_16x16x32_bf16 v[128:131], v[24:27], v[32:35], 0
  ds_read_b64_tr_b16 v[20:21], v3 offset:7232
  v_mfma_f32_16x16x32_bf16 v[132:135], v[24:27], v[36:39], 0
  ds_read_b64_tr_b16 v[22:23], v3 offset:8768
  v_add_u32 v1, 0xfffe9400, v1
  v_add_u32 v2, 0xfffe9400, v2
  v_add_u32 v3, 0xfffe9400, v3
  v_add_u32 v7, 0x4000, v7
  v_add_u32 v5, 0x4000, v5
  ds_read_b128 v[32:35], v7 offset:0
  ds_read_b128 v[36:39], v7 offset:2048
  v_mfma_f32_16x16x32_bf16 v[96:99], v[28:31], v[40:43], v[96:99]
  ds_read_b64_tr_b16 v[24:25], v1 offset:0
  v_mfma_f32_16x16x32_bf16 v[100:103], v[28:31], v[44:47], v[100:103]
  ds_read_b64_tr_b16 v[26:27], v1 offset:1024
  s_waitcnt lgkmcnt(8)
  v_mfma_f32_16x16x32_bf16 v[104:107], v[8:11], v[40:43], v[104:107]
  ds_read_b64_tr_b16 v[28:29], v2 offset:0
  v_mfma_f32_16x16x32_bf16 v[108:111], v[8:11], v[44:47], v[108:111]
  ds_read_b64_tr_b16 v[30:31], v2 offset:1024
  v_mfma_f32_16x16x32_bf16 v[112:115], v[12:15], v[40:43], v[112:115]
  ds_read_b64_tr_b16 v[8:9], v3 offset:2048
  v_mfma_f32_16x16x32_bf16 v[116:119], v[12:15], v[44:47], v[116:119]
  ds_read_b64_tr_b16 v[10:11], v3 offset:3584
  s_waitcnt lgkmcnt(8)
  v_mfma_f32_16x16x32_bf16 v[120:123], v[16:19], v[40:43], v[120:123]
  ds_read_b64_tr_b16 v[12:13], v3 offset:2080
  v_mfma_f32_16x16x32_bf16 v[124:127], v[16:19], v[44:47], v[124:127]
  ds_read_b64_tr_b16 v[14:15], v3 offset:3616
  v_readfirstlane_b32 s63, v164
  s_add_u32 s62, s24, 0xf90000
  s_cmp_lg_u32 s63, 3
  s_cbranch_scc1 NOFLAG_21
  v_mov_b32 v164, s61
  s_mov_b64 exec, 1
  buffer_store_dword v164, off, s[40:43], s62 sc1
  s_mov_b64 exec, -1
NOFLAG_21:
  s_mov_b64 exec, 1
  ds_add_u32 v6, v165 offset:160
  s_mov_b64 exec, -1
  v_mfma_f32_16x16x32_bf16 v[128:131], v[20:23], v[40:43], v[128:131]
  ds_read_b64_tr_b16 v[16:17], v3 offset:2112
  v_mfma_f32_16x16x32_bf16 v[132:135], v[20:23], v[44:47], v[132:135]
  ds_read_b64_tr_b16 v[18:19], v3 offset:3648
  ds_read_b128 v[40:43], v5 offset:0
  ds_read_b128 v[44:47], v5 offset:2048
  s_waitcnt lgkmcnt(9)
  v_mfma_f32_16x16x32_bf16 v[96:99], v[24:27], v[32:35], v[96:99]
  ds_read_b64_tr_b16 v[20:21], v1 offset:5120
  v_mfma_f32_16x16x32_bf16 v[100:103], v[24:27], v[36:39], v[100:103]
  ds_read_b64_tr_b16 v[22:23], v1 offset:6144
  v_mfma_f32_16x16x32_bf16 v[104:107], v[28:31], v[32:35], v[104:107]
  ds_read_b64_tr_b16 v[24:25], v2 offset:5120
  v_mfma_f32_16x16x32_bf16 v[108:111], v[28:31], v[36:39], v[108:111]
  ds_read_b64_tr_b16 v[26:27], v2 offset:6144
  s_waitcnt lgkmcnt(9)
  v_mfma_f32_16x16x32_bf16 v[112:115], v[8:11], v[32:35], v[112:115]
  ds_read_b64_tr_b16 v[28:29], v3 offset:7168
  v_mfma_f32_16x16x32_bf16 v[116:119], v[8:11], v[36:39], v[116:119]
  ds_read_b64_tr_b16 v[30:31], v3 offset:8704
  v_mfma_f32_16x16x32_bf16 v[120:123], v[12:15], v[32:35], v[120:123]
  ds_read_b64_tr_b16 v[8:9], v3 offset:7200
  v_mfma_f32_16x16x32_bf16 v[124:127], v[12:15], v[36:39], v[124:127]
  ds_read_b64_tr_b16 v[10:11], v3 offset:8736
  s_waitcnt lgkmcnt(6)
  v_mfma_f32_16x16x32_bf16 v[128:131], v[16:19], v[32:35], v[128:131]
  ds_read_b64_tr_b16 v[12:13], v3 offset:7232
  v_mfma_f32_16x16x32_bf16 v[132:135], v[16:19], v[36:39], v[132:135]
  ds_read_b64_tr_b16 v[14:15], v3 offset:8768
  v_add_u32 v1, 0xffffd400, v1
  v_add_u32 v2, 0xffffd400, v2
  v_add_u32 v3, 0xffffd400, v3
  v_add_u32 v7, 0x4000, v7
  v_add_u32 v5, 0x4000, v5
  ds_read_b128 v[32:35], v7 offset:0
  ds_read_b128 v[36:39], v7 offset:2048
  v_mfma_f32_16x16x32_bf16 v[96:99], v[20:23], v[40:43], v[96:99]
  ds_read_b64_tr_b16 v[16:17], v1 offset:0
  v_mfma_f32_16x16x32_bf16 v[100:103], v[20:23], v[44:47], v[100:103]
  ds_read_b64_tr_b16 v[18:19], v1 offset:1024
  s_waitcnt lgkmcnt(8)
  v_mfma_f32_16x16x32_bf16 v[104:107], v[24:27], v[40:43], v[104:107]
  ds_read_b64_tr_b16 v[20:21], v2 offset:0
  v_mfma_f32_16x16x32_bf16 v[108:111], v[24:27], v[44:47], v[108:111]
  ds_read_b64_tr_b16 v[22:23], v2 offset:1024
  v_mfma_f32_16x16x32_bf16 v[112:115], v[28:31], v[40:43], v[112:115]
  ds_read_b64_tr_b16 v[24:25], v3 offset:2048
  v_mfma_f32_16x16x32_bf16 v[116:119], v[28:31], v[44:47], v[116:119]
  ds_read_b64_tr_b16 v[26:27], v3 offset:3584
  s_waitcnt lgkmcnt(8)
  v_mfma_f32_16x16x32_bf16 v[120:123], v[8:11], v[40:43], v[120:123]
  ds_read_b64_tr_b16 v[28:29], v3 offset:2080
  v_mfma_f32_16x16x32_bf16 v[124:127], v[8:11], v[44:47], v[124:127]
  ds_read_b64_tr_b16 v[30:31], v3 offset:3616
  s_mov_b64 exec, 1
  ds_add_u32 v6, v165 offset:164
  s_mov_b64 exec, -1
  v_mfma_f32_16x16x32_bf16 v[128:131], v[12:15], v[40:43], v[128:131]
  ds_read_b64_tr_b16 v[8:9], v3 offset:2112
  v_mfma_f32_16x16x32_bf16 v[132:135], v[12:15], v[44:47], v[132:135]
  ds_read_b64_tr_b16 v[10:11], v3 offset:3648
  ds_read_b128 v[40:43], v5 offset:0
  ds_read_b128 v[44:47], v5 offset:2048
  s_waitcnt lgkmcnt(9)
  v_mfma_f32_16x16x32_bf16 v[96:99], v[16:19], v[32:35], v[96:99]
  ds_read_b64_tr_b16 v[12:13], v1 offset:5120
  v_mfma_f32_16x16x32_bf16 v[100:103], v[16:19], v[36:39], v[100:103]
  ds_read_b64_tr_b16 v[14:15], v1 offset:6144
  v_mfma_f32_16x16x32_bf16 v[104:107], v[20:23], v[32:35], v[104:107]
  ds_read_b64_tr_b16 v[16:17], v2 offset:5120
  v_mfma_f32_16x16x32_bf16 v[108:111], v[20:23], v[36:39], v[108:111]
  ds_read_b64_tr_b16 v[18:19], v2 offset:6144
  s_waitcnt lgkmcnt(9)
  v_mfma_f32_16x16x32_bf16 v[112:115], v[24:27], v[32:35], v[112:115]
  ds_read_b64_tr_b16 v[20:21], v3 offset:7168
  v_mfma_f32_16x16x32_bf16 v[116:119], v[24:27], v[36:39], v[116:119]
  ds_read_b64_tr_b16 v[22:23], v3 offset:8704
  v_mfma_f32_16x16x32_bf16 v[120:123], v[28:31], v[32:35], v[120:123]
  ds_read_b64_tr_b16 v[24:25], v3 offset:7200
  v_mfma_f32_16x16x32_bf16 v[124:127], v[28:31], v[36:39], v[124:127]
  ds_read_b64_tr_b16 v[26:27], v3 offset:8736
  s_waitcnt lgkmcnt(6)
  v_mfma_f32_16x16x32_bf16 v[128:131], v[8:11], v[32:35], v[128:131]
  ds_read_b64_tr_b16 v[28:29], v3 offset:7232
  v_mfma_f32_16x16x32_bf16 v[132:135], v[8:11], v[36:39], v[132:135]
  ds_read_b64_tr_b16 v[30:31], v3 offset:8768
  v_add_u32 v1, 0xffffd400, v1
  v_add_u32 v2, 0xffffd400, v2
  v_add_u32 v3, 0xffffd400, v3
  s_waitcnt vmcnt(0)
  s_mov_b64 exec, 1
  ds_add_rtn_u32 v164, v6, v165 offset:24
  s_mov_b64 exec, -1
  v_add_u32 v7, 0x4000, v7
  v_add_u32 v5, 0x4000, v5
  ds_read_b128 v[32:35], v7 offset:0
  ds_read_b128 v[36:39], v7 offset:2048
  v_mfma_f32_16x16x32_bf16 v[96:99], v[12:15], v[40:43], v[96:99]
  ds_read_b64_tr_b16 v[8:9], v1 offset:0
  v_mfma_f32_16x16x32_bf16 v[100:103], v[12:15], v[44:47], v[100:103]
  ds_read_b64_tr_b16 v[10:11], v1 offset:1024
  s_waitcnt lgkmcnt(9)
  v_mfma_f32_16x16x32_bf16 v[104:107], v[16:19], v[40:43], v[104:107]
  ds_read_b64_tr_b16 v[12:13], v2 offset:0
  v_mfma_f32_16x16x32_bf16 v[108:111], v[16:19], v[44:47], v[108:111]
  ds_read_b64_tr_b16 v[14:15], v2 offset:1024
  v_mfma_f32_16x16x32_bf16 v[112:115], v[20:23], v[40:43], v[112:115]
  ds_read_b64_tr_b16 v[16:17], v3 offset:2048
  v_mfma_f32_16x16x32_bf16 v[116:119], v[20:23], v[44:47], v[116:119]
  ds_read_b64_tr_b16 v[18:19], v3 offset:3584
  s_waitcnt lgkmcnt(9)
  v_mfma_f32_16x16x32_bf16 v[120:123], v[24:27], v[40:43], v[120:123]
  ds_read_b64_tr_b16 v[20:21], v3 offset:2080
  v_mfma_f32_16x16x32_bf16 v[124:127], v[24:27], v[44:47], v[124:127]
  ds_read_b64_tr_b16 v[22:23], v3 offset:3616
  s_waitcnt lgkmcnt(10)
  v_readfirstlane_b32 s63, v164
  s_add_u32 s62, s24, 0xfc0000
  s_cmp_lg_u32 s63, 3
  s_cbranch_scc1 NOFLAG_22
  v_mov_b32 v164, s61
  s_mov_b64 exec, 1
  buffer_store_dword v164, off, s[40:43], s62 sc1
  s_mov_b64 exec, -1
NOFLAG_22:
  s_mov_b64 exec, 1
  ds_add_u32 v6, v165 offset:168
  s_mov_b64 exec, -1
  v_mfma_f32_16x16x32_bf16 v[128:131], v[28:31], v[40:43], v[128:131]
  ds_read_b64_tr_b16 v[24:25], v3 offset:2112
  v_mfma_f32_16x16x32_bf16 v[132:135], v[28:31], v[44:47], v[132:135]
  ds_read_b64_tr_b16 v[26:27], v3 offset:3648
  ds_read_b128 v[40:43], v5 offset:0
  ds_read_b128 v[44:47], v5 offset:2048
  s_waitcnt lgkmcnt(9)
  v_mfma_f32_16x16x32_bf16 v[96:99], v[8:11], v[32:35], v[96:99]
  ds_read_b64_tr_b16 v[28:29], v1 offset:5120
  v_mfma_f32_16x16x32_bf16 v[100:103], v[8:11], v[36:39], v[100:103]
  ds_read_b64_tr_b16 v[30:31], v1 offset:6144
  v_mfma_f32_16x16x32_bf16 v[104:107], v[12:15], v[32:35], v[104:107]
  ds_read_b64_tr_b16 v[8:9], v2 offset:5120
  v_mfma_f32_16x16x32_bf16 v[108:111], v[12:15], v[36:39], v[108:111]
  ds_read_b64_tr_b16 v[10:11], v2 offset:6144
  s_waitcnt lgkmcnt(9)
  v_mfma_f32_16x16x32_bf16 v[112:115], v[16:19], v[32:35], v[112:115]
  ds_read_b64_tr_b16 v[12:13], v3 offset:7168
  v_mfma_f32_16x16x32_bf16 v[116:119], v[16:19], v[36:39], v[116:119]
  ds_read_b64_tr_b16 v[14:15], v3 offset:8704
  v_mfma_f32_16x16x32_bf16 v[120:123], v[20:23], v[32:35], v[120:123]
  ds_read_b64_tr_b16 v[16:17], v3 offset:7200
  v_mfma_f32_16x16x32_bf16 v[124:127], v[20:23], v[36:39], v[124:127]
  ds_read_b64_tr_b16 v[18:19], v3 offset:8736
  s_waitcnt lgkmcnt(6)
  v_mfma_f32_16x16x32_bf16 v[128:131], v[24:27], v[32:35], v[128:131]
  ds_read_b64_tr_b16 v[20:21], v3 offset:7232
  v_mfma_f32_16x16x32_bf16 v[132:135], v[24:27], v[36:39], v[132:135]
  ds_read_b64_tr_b16 v[22:23], v3 offset:8768
  v_add_u32 v1, 0xffffd400, v1
  v_add_u32 v2, 0xffffd400, v2
  v_add_u32 v3, 0xffffd400, v3
  v_add_u32 v7, 0x4000, v7
  v_add_u32 v5, 0x4000, v5
  ds_read_b128 v[32:35], v7 offset:0
  ds_read_b128 v[36:39], v7 offset:2048
  v_mfma_f32_16x16x32_bf16 v[96:99], v[28:31], v[40:43], v[96:99]
  ds_read_b64_tr_b16 v[24:25], v1 offset:0
  v_mfma_f32_16x16x32_bf16 v[100:103], v[28:31], v[44:47], v[100:103]
  ds_read_b64_tr_b16 v[26:27], v1 offset:1024
  s_waitcnt lgkmcnt(8)
  v_mfma_f32_16x16x32_bf16 v[104:107], v[8:11], v[40:43], v[104:107]
  ds_read_b64_tr_b16 v[28:29], v2 offset:0
  v_mfma_f32_16x16x32_bf16 v[108:111], v[8:11], v[44:47], v[108:111]
  ds_read_b64_tr_b16 v[30:31], v2 offset:1024
  v_mfma_f32_16x16x32_bf16 v[112:115], v[12:15], v[40:43], v[112:115]
  ds_read_b64_tr_b16 v[8:9], v3 offset:2048
  v_mfma_f32_16x16x32_bf16 v[116:119], v[12:15], v[44:47], v[116:119]
  ds_read_b64_tr_b16 v[10:11], v3 offset:3584
  s_waitcnt lgkmcnt(8)
  v_mfma_f32_16x16x32_bf16 v[120:123], v[16:19], v[40:43], v[120:123]
  ds_read_b64_tr_b16 v[12:13], v3 offset:2080
  v_mfma_f32_16x16x32_bf16 v[124:127], v[16:19], v[44:47], v[124:127]
  ds_read_b64_tr_b16 v[14:15], v3 offset:3616
  s_mov_b64 exec, 1
  ds_add_u32 v6, v165 offset:172
  s_mov_b64 exec, -1
  v_mfma_f32_16x16x32_bf16 v[128:131], v[20:23], v[40:43], v[128:131]
  ds_read_b64_tr_b16 v[16:17], v3 offset:2112
  v_mfma_f32_16x16x32_bf16 v[132:135], v[20:23], v[44:47], v[132:135]
  ds_read_b64_tr_b16 v[18:19], v3 offset:3648
  ds_read_b128 v[40:43], v5 offset:0
  ds_read_b128 v[44:47], v5 offset:2048
  s_waitcnt lgkmcnt(9)
  v_mfma_f32_16x16x32_bf16 v[96:99], v[24:27], v[32:35], v[96:99]
  ds_read_b64_tr_b16 v[20:21], v1 offset:5120
  v_mfma_f32_16x16x32_bf16 v[100:103], v[24:27], v[36:39], v[100:103]
  ds_read_b64_tr_b16 v[22:23], v1 offset:6144
  v_mfma_f32_16x16x32_bf16 v[104:107], v[28:31], v[32:35], v[104:107]
  ds_read_b64_tr_b16 v[24:25], v2 offset:5120
  v_mfma_f32_16x16x32_bf16 v[108:111], v[28:31], v[36:39], v[108:111]
  ds_read_b64_tr_b16 v[26:27], v2 offset:6144
  s_waitcnt lgkmcnt(9)
  v_mfma_f32_16x16x32_bf16 v[112:115], v[8:11], v[32:35], v[112:115]
  ds_read_b64_tr_b16 v[28:29], v3 offset:7168
  v_mfma_f32_16x16x32_bf16 v[116:119], v[8:11], v[36:39], v[116:119]
  ds_read_b64_tr_b16 v[30:31], v3 offset:8704
  v_mfma_f32_16x16x32_bf16 v[120:123], v[12:15], v[32:35], v[120:123]
  ds_read_b64_tr_b16 v[8:9], v3 offset:7200
  v_mfma_f32_16x16x32_bf16 v[124:127], v[12:15], v[36:39], v[124:127]
  ds_read_b64_tr_b16 v[10:11], v3 offset:8736
  s_waitcnt lgkmcnt(6)
  v_mfma_f32_16x16x32_bf16 v[128:131], v[16:19], v[32:35], v[128:131]
  ds_read_b64_tr_b16 v[12:13], v3 offset:7232
  v_mfma_f32_16x16x32_bf16 v[132:135], v[16:19], v[36:39], v[132:135]
  ds_read_b64_tr_b16 v[14:15], v3 offset:8768
  v_add_u32 v1, 0xffffd400, v1
  v_add_u32 v2, 0xffffd400, v2
  v_add_u32 v3, 0xffffd400, v3
  v_mfma_f32_16x16x32_bf16 v[96:99], v[20:23], v[40:43], v[96:99]
  ds_read_b64_tr_b16 v[16:17], v1 offset:0
  v_mfma_f32_16x16x32_bf16 v[100:103], v[20:23], v[44:47], v[100:103]
  ds_read_b64_tr_b16 v[18:19], v1 offset:1024
  s_waitcnt lgkmcnt(6)
  v_mfma_f32_16x16x32_bf16 v[104:107], v[24:27], v[40:43], v[104:107]
  ds_read_b64_tr_b16 v[20:21], v2 offset:0
  v_mfma_f32_16x16x32_bf16 v[108:111], v[24:27], v[44:47], v[108:111]
  ds_read_b64_tr_b16 v[22:23], v2 offset:1024
  v_mfma_f32_16x16x32_bf16 v[112:115], v[28:31], v[40:43], v[112:115]
  ds_read_b64_tr_b16 v[24:25], v3 offset:2048
  v_mfma_f32_16x16x32_bf16 v[116:119], v[28:31], v[44:47], v[116:119]
  ds_read_b64_tr_b16 v[26:27], v3 offset:3584
  s_waitcnt lgkmcnt(6)
  v_mfma_f32_16x16x32_bf16 v[120:123], v[8:11], v[40:43], v[120:123]
  ds_read_b64_tr_b16 v[28:29], v3 offset:2080
  v_mfma_f32_16x16x32_bf16 v[124:127], v[8:11], v[44:47], v[124:127]
  ds_read_b64_tr_b16 v[30:31], v3 offset:3616
  s_mov_b64 exec, 1
  ds_add_u32 v6, v165 offset:176
  s_mov_b64 exec, -1
  v_mfma_f32_16x16x32_bf16 v[128:131], v[12:15], v[40:43], v[128:131]
  ds_read_b64_tr_b16 v[8:9], v3 offset:2112
  v_mfma_f32_16x16x32_bf16 v[132:135], v[12:15], v[44:47], v[132:135]
  ds_read_b64_tr_b16 v[10:11], v3 offset:3648
  s_waitcnt lgkmcnt(7)
  v_mfma_f32_16x16x32_bf16 v[96:99], v[16:19], v[48:51], v[96:99]
  ds_read_b64_tr_b16 v[12:13], v1 offset:5120
  v_mfma_f32_16x16x32_bf16 v[100:103], v[16:19], v[52:55], v[100:103]
  ds_read_b64_tr_b16 v[14:15], v1 offset:6144
  ds_read_b32 v4, v6 offset:120
  v_mfma_f32_16x16x32_bf16 v[104:107], v[20:23], v[48:51], v[104:107]
  ds_read_b64_tr_b16 v[16:17], v2 offset:5120
  v_mfma_f32_16x16x32_bf16 v[108:111], v[20:23], v[52:55], v[108:111]
  ds_read_b64_tr_b16 v[18:19], v2 offset:6144
  s_waitcnt lgkmcnt(8)
  v_mfma_f32_16x16x32_bf16 v[112:115], v[24:27], v[48:51], v[112:115]
  ds_read_b64_tr_b16 v[20:21], v3 offset:7168
  v_mfma_f32_16x16x32_bf16 v[116:119], v[24:27], v[52:55], v[116:119]
  ds_read_b64_tr_b16 v[22:23], v3 offset:8704
  v_mfma_f32_16x16x32_bf16 v[120:123], v[28:31], v[48:51], v[120:123]
  ds_read_b64_tr_b16 v[24:25], v3 offset:7200
  v_mfma_f32_16x16x32_bf16 v[124:127], v[28:31], v[52:55], v[124:127]
  ds_read_b64_tr_b16 v[26:27], v3 offset:8736
  s_waitcnt lgkmcnt(7)
  v_mfma_f32_16x16x32_bf16 v[128:131], v[8:11], v[48:51], v[128:131]
  ds_read_b64_tr_b16 v[28:29], v3 offset:7232
  v_mfma_f32_16x16x32_bf16 v[132:135], v[8:11], v[52:55], v[132:135]
  ds_read_b64_tr_b16 v[30:31], v3 offset:8768
  v_add_u32 v1, 0x21c00, v1
  v_add_u32 v2, 0x21c00, v2
  v_add_u32 v3, 0x21c00, v3
  s_waitcnt lgkmcnt(8)
  v_readfirstlane_b32 s62, v4
  s_cmp_ge_u32 s62, 4
  s_cbranch_scc1 FOK_24
  s_mov_b32 s63, 0x400000
LW_25:
  ds_read_b32 v4, v6 offset:120
  s_sub_u32 s63, s63, 1
  s_waitcnt lgkmcnt(0)
  v_readfirstlane_b32 s62, v4
  s_cmp_eq_u32 s63, 0
  s_cbranch_scc1 LWOK_26
  s_cmp_ge_u32 s62, 4
  s_cbranch_scc1 LWOK_26
  s_sleep 1
  s_branch LW_25
LWOK_26:
FOK_24:
  v_mfma_f32_16x16x32_bf16 v[96:99], v[12:15], v[56:59], v[96:99]
  ds_read_b64_tr_b16 v[8:9], v1 offset:0
  v_mfma_f32_16x16x32_bf16 v[100:103], v[12:15], v[60:63], v[100:103]
  ds_read_b64_tr_b16 v[10:11], v1 offset:1024
  s_waitcnt lgkmcnt(6)
  v_mfma_f32_16x16x32_bf16 v[104:107], v[16:19], v[56:59], v[104:107]
  ds_read_b64_tr_b16 v[12:13], v2 offset:0
  v_mfma_f32_16x16x32_bf16 v[108:111], v[16:19], v[60:63], v[108:111]
  ds_read_b64_tr_b16 v[14:15], v2 offset:1024
  v_mfma_f32_16x16x32_bf16 v[112:115], v[20:23], v[56:59], v[112:115]
  ds_read_b64_tr_b16 v[16:17], v3 offset:2048
  v_mfma_f32_16x16x32_bf16 v[116:119], v[20:23], v[60:63], v[116:119]
  ds_read_b64_tr_b16 v[18:19], v3 offset:3584
  s_waitcnt lgkmcnt(6)
  v_mfma_f32_16x16x32_bf16 v[120:123], v[24:27], v[56:59], v[120:123]
  ds_read_b64_tr_b16 v[20:21], v3 offset:2080
  v_mfma_f32_16x16x32_bf16 v[124:127], v[24:27], v[60:63], v[124:127]
  ds_read_b64_tr_b16 v[22:23], v3 offset:3616
  s_mov_b64 exec, 1
  ds_add_u32 v6, v165 offset:180
  s_mov_b64 exec, -1
  v_mfma_f32_16x16x32_bf16 v[128:131], v[28:31], v[56:59], v[128:131]
  ds_read_b64_tr_b16 v[24:25], v3 offset:2112
  v_mfma_f32_16x16x32_bf16 v[132:135], v[28:31], v[60:63], v[132:135]
  ds_read_b64_tr_b16 v[26:27], v3 offset:3648
  s_waitcnt lgkmcnt(7)
  v_mfma_f32_16x16x32_bf16 v[96:99], v[8:11], v[64:67], v[96:99]
  ds_read_b64_tr_b16 v[28:29], v1 offset:5120
  v_mfma_f32_16x16x32_bf16 v[100:103], v[8:11], v[68:71], v[100:103]
  ds_read_b64_tr_b16 v[30:31], v1 offset:6144
  ds_read_b32 v4, v6 offset:124
  v_mfma_f32_16x16x32_bf16 v[104:107], v[12:15], v[64:67], v[104:107]
  ds_read_b64_tr_b16 v[8:9], v2 offset:5120
  v_mfma_f32_16x16x32_bf16 v[108:111], v[12:15], v[68:71], v[108:111]
  ds_read_b64_tr_b16 v[10:11], v2 offset:6144
  s_waitcnt lgkmcnt(8)
  v_mfma_f32_16x16x32_bf16 v[112:115], v[16:19], v[64:67], v[112:115]
  ds_read_b64_tr_b16 v[12:13], v3 offset:7168
  v_mfma_f32_16x16x32_bf16 v[116:119], v[16:19], v[68:71], v[116:119]
  ds_read_b64_tr_b16 v[14:15], v3 offset:8704
  v_mfma_f32_16x16x32_bf16 v[120:123], v[20:23], v[64:67], v[120:123]
  ds_read_b64_tr_b16 v[16:17], v3 offset:7200
  v_mfma_f32_16x16x32_bf16 v[124:127], v[20:23], v[68:71], v[124:127]
  ds_read_b64_tr_b16 v[18:19], v3 offset:8736
  s_waitcnt lgkmcnt(7)
  v_mfma_f32_16x16x32_bf16 v[128:131], v[24:27], v[64:67], v[128:131]
  ds_read_b64_tr_b16 v[20:21], v3 offset:7232
  v_mfma_f32_16x16x32_bf16 v[132:135], v[24:27], v[68:71], v[132:135]
  ds_read_b64_tr_b16 v[22:23], v3 offset:8768
  v_add_u32 v1, 0xfffe9400, v1
  v_add_u32 v2, 0xfffe9400, v2
  v_add_u32 v3, 0xfffe9400, v3
  s_waitcnt lgkmcnt(8)
  v_readfirstlane_b32 s62, v4
  s_cmp_ge_u32 s62, 4
  s_cbranch_scc1 FOK_28
  s_mov_b32 s63, 0x400000
LW_29:
  ds_read_b32 v4, v6 offset:124
  s_sub_u32 s63, s63, 1
  s_waitcnt lgkmcnt(0)
  v_readfirstlane_b32 s62, v4
  s_cmp_eq_u32 s63, 0
  s_cbranch_scc1 LWOK_30
  s_cmp_ge_u32 s62, 4
  s_cbranch_scc1 LWOK_30
  s_sleep 1
  s_branch LW_29
LWOK_30:
FOK_28:
  v_mfma_f32_16x16x32_bf16 v[96:99], v[28:31], v[72:75], v[96:99]
  ds_read_b64_tr_b16 v[24:25], v1 offset:0
  v_mfma_f32_16x16x32_bf16 v[100:103], v[28:31], v[76:79], v[100:103]
  ds_read_b64_tr_b16 v[26:27], v1 offset:1024
  s_waitcnt lgkmcnt(6)
  v_mfma_f32_16x16x32_bf16 v[104:107], v[8:11], v[72:75], v[104:107]
  ds_read_b64_tr_b16 v[28:29], v2 offset:0
  v_mfma_f32_16x16x32_bf16 v[108:111], v[8:11], v[76:79], v[108:111]
  ds_read_b64_tr_b16 v[30:31], v2 offset:1024
  v_mfma_f32_16x16x32_bf16 v[112:115], v[12:15], v[72:75], v[112:115]
  ds_read_b64_tr_b16 v[8:9], v3 offset:2048
  v_mfma_f32_16x16x32_bf16 v[116:119], v[12:15], v[76:79], v[116:119]
  ds_read_b64_tr_b16 v[10:11], v3 offset:3584
  s_waitcnt lgkmcnt(6)
  v_mfma_f32_16x16x32_bf16 v[120:123], v[16:19], v[72:75], v[120:123]
  ds_read_b64_tr_b16 v[12:13], v3 offset:2080
  v_mfma_f32_16x16x32_bf16 v[124:127], v[16:19], v[76:79], v[124:127]
  ds_read_b64_tr_b16 v[14:15], v3 offset:3616
  s_mov_b64 exec, 1
  ds_add_u32 v6, v165 offset:184
  s_mov_b64 exec, -1
  v_mfma_f32_16x16x32_bf16 v[128:131], v[20:23], v[72:75], v[128:131]
  ds_read_b64_tr_b16 v[16:17], v3 offset:2112
  v_mfma_f32_16x16x32_bf16 v[132:135], v[20:23], v[76:79], v[132:135]
  ds_read_b64_tr_b16 v[18:19], v3 offset:3648
  s_waitcnt lgkmcnt(7)
  v_mfma_f32_16x16x32_bf16 v[96:99], v[24:27], v[80:83], v[96:99]
  ds_read_b64_tr_b16 v[20:21], v1 offset:5120
  v_mfma_f32_16x16x32_bf16 v[100:103], v[24:27], v[84:87], v[100:103]
  ds_read_b64_tr_b16 v[22:23], v1 offset:6144
  v_mfma_f32_16x16x32_bf16 v[104:107], v[28:31], v[80:83], v[104:107]
  ds_read_b64_tr_b16 v[24:25], v2 offset:5120
  v_mfma_f32_16x16x32_bf16 v[108:111], v[28:31], v[84:87], v[108:111]
  ds_read_b64_tr_b16 v[26:27], v2 offset:6144
  s_waitcnt lgkmcnt(7)
  v_mfma_f32_16x16x32_bf16 v[112:115], v[8:11], v[80:83], v[112:115]
  ds_read_b64_tr_b16 v[28:29], v3 offset:7168
  v_mfma_f32_16x16x32_bf16 v[116:119], v[8:11], v[84:87], v[116:119]
  ds_read_b64_tr_b16 v[30:31], v3 offset:8704
  v_mfma_f32_16x16x32_bf16 v[120:123], v[12:15], v[80:83], v[120:123]
  ds_read_b64_tr_b16 v[8:9], v3 offset:7200
  v_mfma_f32_16x16x32_bf16 v[124:127], v[12:15], v[84:87], v[124:127]
  ds_read_b64_tr_b16 v[10:11], v3 offset:8736
  s_waitcnt lgkmcnt(6)
  v_mfma_f32_16x16x32_bf16 v[128:131], v[16:19], v[80:83], v[128:131]
  ds_read_b64_tr_b16 v[12:13], v3 offset:7232
  v_mfma_f32_16x16x32_bf16 v[132:135], v[16:19], v[84:87], v[132:135]
  ds_read_b64_tr_b16 v[14:15], v3 offset:8768
  v_mfma_f32_16x16x32_bf16 v[96:99], v[20:23], v[88:91], v[96:99]
  v_mfma_f32_16x16x32_bf16 v[100:103], v[20:23], v[92:95], v[100:103]
  s_waitcnt lgkmcnt(4)
  v_mfma_f32_16x16x32_bf16 v[104:107], v[24:27], v[88:91], v[104:107]
  v_mfma_f32_16x16x32_bf16 v[108:111], v[24:27], v[92:95], v[108:111]
  v_mfma_f32_16x16x32_bf16 v[112:115], v[28:31], v[88:91], v[112:115]
  v_mfma_f32_16x16x32_bf16 v[116:119], v[28:31], v[92:95], v[116:119]
  s_waitcnt lgkmcnt(0)
  v_mfma_f32_16x16x32_bf16 v[120:123], v[8:11], v[88:91], v[120:123]
  v_mfma_f32_16x16x32_bf16 v[124:127], v[8:11], v[92:95], v[124:127]
  s_mov_b64 exec, 1
  ds_add_u32 v6, v165 offset:188
  s_mov_b64 exec, -1
  v_mfma_f32_16x16x32_bf16 v[128:131], v[12:15], v[88:91], v[128:131]
  v_mfma_f32_16x16x32_bf16 v[132:135], v[12:15], v[92:95], v[132:135]
  v_and_b32 v16, 15, v0
  v_lshrrev_b32 v17, 4, v0
  s_lshl_b32 s3, s19, 9
  s_add_u32 s3, s3, 158720
  v_lshl_add_u32 v8, v16, 4, s3
  v_lshlrev_b32 v164, 4, v17
  v_add_u32 v164, 160768, v164
  v_mov_b32 v10, 161792
  ds_read_b128 v[24:27], v164 offset:512
  v_lshlrev_b32 v166, 4, v0
  s_mov_b32 s3, 0x3eb8aa3b
  v_mul_f32 v32, s3, v160
  v_mul_f32 v33, s3, v161
  v_mul_f32 v34, s3, v162
  v_mul_f32 v35, s3, v163
  s_lshl_b32 s3, s19, 10
  s_add_u32 s3, s3, 147456
  v_add_u32 v36, s3, v166
  v_mov_b32 v37, 161792
  s_mov_b32 s63, 0x400000
LW_31:
  ds_read_b32 v38, v37 offset:184
  s_sub_u32 s63, s63, 1
  s_waitcnt lgkmcnt(0)
  v_readfirstlane_b32 s62, v38
  s_cmp_eq_u32 s63, 0
  s_cbranch_scc1 LWOK_32
  s_cmp_ge_u32 s62, 4
  s_cbranch_scc1 LWOK_32
  s_sleep 1
  s_branch LW_31
LWOK_32:
  ds_read_b128 v[28:31], v164 offset:576
  v_mul_f32 v8, v24, v33
  v_mul_f32 v9, v25, v33
  v_mul_f32 v10, v26, v33
  v_mul_f32 v11, v27, v33
  v_mul_f32 v12, v24, v35
  v_mul_f32 v13, v25, v35
  v_mul_f32 v14, v26, v35
  v_mul_f32 v15, v27, v35
  v_fmac_f32 v8, v96, v32
  v_fmac_f32 v9, v97, v32
  v_fmac_f32 v10, v98, v32
  v_fmac_f32 v11, v99, v32
  v_fmac_f32 v12, v100, v34
  v_fmac_f32 v13, v101, v34
  v_fmac_f32 v14, v102, v34
  v_fmac_f32 v15, v103, v34
  v_cvt_pk_bf16_f32 v16, v8, v9
  v_cvt_pk_bf16_f32 v17, v10, v11
  v_cvt_pk_bf16_f32 v18, v12, v13
  v_cvt_pk_bf16_f32 v19, v14, v15
  s_nop 2
  v_permlane16_swap_b32 v16, v18
  v_permlane16_swap_b32 v17, v19
  s_nop 0
  s_nop 0
  ds_write_b128 v36, v[16:19] offset:0
  s_waitcnt lgkmcnt(1)
  ds_read_b128 v[24:27], v164 offset:640
  v_mul_f32 v8, v28, v33
  v_mul_f32 v9, v29, v33
  v_mul_f32 v10, v30, v33
  v_mul_f32 v11, v31, v33
  v_mul_f32 v12, v28, v35
  v_mul_f32 v13, v29, v35
  v_mul_f32 v14, v30, v35
  v_mul_f32 v15, v31, v35
  v_fmac_f32 v8, v104, v32
  v_fmac_f32 v9, v105, v32
  v_fmac_f32 v10, v106, v32
  v_fmac_f32 v11, v107, v32
  v_fmac_f32 v12, v108, v34
  v_fmac_f32 v13, v109, v34
  v_fmac_f32 v14, v110, v34
  v_fmac_f32 v15, v111, v34
  v_cvt_pk_bf16_f32 v20, v8, v9
  v_cvt_pk_bf16_f32 v21, v10, v11
  v_cvt_pk_bf16_f32 v22, v12, v13
  v_cvt_pk_bf16_f32 v23, v14, v15
  s_nop 2
  v_permlane16_swap_b32 v20, v22
  v_permlane16_swap_b32 v21, v23
  s_nop 0
  s_nop 0
  ds_write_b128 v36, v[20:23] offset:4096
  s_waitcnt lgkmcnt(0)
  v_mov_b32 v37, 161792
  v_mov_b32 v38, 1
  s_mov_b64 exec, 1
  ds_add_u32 v37, v38 offset:16
  s_mov_b64 exec, -1
  ds_read_b128 v[28:31], v164 offset:704
  v_mul_f32 v8, v24, v161
  v_mul_f32 v9, v25, v161
  v_mul_f32 v10, v26, v161
  v_mul_f32 v11, v27, v161
  v_mul_f32 v12, v24, v163
  v_mul_f32 v13, v25, v163
  v_mul_f32 v14, v26, v163
  v_mul_f32 v15, v27, v163
  v_fmac_f32 v8, v112, v160
  v_fmac_f32 v9, v113, v160
  v_fmac_f32 v10, v114, v160
  v_fmac_f32 v11, v115, v160
  v_fmac_f32 v12, v116, v162
  v_fmac_f32 v13, v117, v162
  v_fmac_f32 v14, v118, v162
  v_fmac_f32 v15, v119, v162
  v_cvt_pk_bf16_f32 v16, v8, v9
  v_cvt_pk_bf16_f32 v17, v10, v11
  v_cvt_pk_bf16_f32 v18, v12, v13
  v_cvt_pk_bf16_f32 v19, v14, v15
  s_nop 2
  v_permlane16_swap_b32 v16, v18
  v_permlane16_swap_b32 v17, v19
  s_add_u32 s3, s55, 0
  s_nop 0
  v_pk_max_i16 v16, v16, 0
  v_pk_max_i16 v18, v18, 0
  v_pk_max_i16 v17, v17, 0
  v_pk_max_i16 v19, v19, 0
  buffer_store_dwordx4 v[16:19], v166, s[40:43], s3 offen sc1
  s_waitcnt lgkmcnt(0)
  ds_read_b128 v[24:27], v164 offset:768
  v_mul_f32 v8, v28, v161
  v_mul_f32 v9, v29, v161
  v_mul_f32 v10, v30, v161
  v_mul_f32 v11, v31, v161
  v_mul_f32 v12, v28, v163
  v_mul_f32 v13, v29, v163
  v_mul_f32 v14, v30, v163
  v_mul_f32 v15, v31, v163
  v_fmac_f32 v8, v120, v160
  v_fmac_f32 v9, v121, v160
  v_fmac_f32 v10, v122, v160
  v_fmac_f32 v11, v123, v160
  v_fmac_f32 v12, v124, v162
  v_fmac_f32 v13, v125, v162
  v_fmac_f32 v14, v126, v162
  v_fmac_f32 v15, v127, v162
  v_cvt_pk_bf16_f32 v20, v8, v9
  v_cvt_pk_bf16_f32 v21, v10, v11
  v_cvt_pk_bf16_f32 v22, v12, v13
  v_cvt_pk_bf16_f32 v23, v14, v15
  s_nop 2
  v_permlane16_swap_b32 v20, v22
  v_permlane16_swap_b32 v21, v23
  s_add_u32 s3, s55, 1024
  s_nop 0
  v_pk_max_i16 v20, v20, 0
  v_pk_max_i16 v22, v22, 0
  v_pk_max_i16 v21, v21, 0
  v_pk_max_i16 v23, v23, 0
  buffer_store_dwordx4 v[20:23], v166, s[40:43], s3 offen sc1
  s_waitcnt lgkmcnt(0)
  v_mul_f32 v8, v24, v161
  v_mul_f32 v9, v25, v161
  v_mul_f32 v10, v26, v161
  v_mul_f32 v11, v27, v161
  v_mul_f32 v12, v24, v163
  v_mul_f32 v13, v25, v163
  v_mul_f32 v14, v26, v163
  v_mul_f32 v15, v27, v163
  v_fmac_f32 v8, v128, v160
  v_fmac_f32 v9, v129, v160
  v_fmac_f32 v10, v130, v160
  v_fmac_f32 v11, v131, v160
  v_fmac_f32 v12, v132, v162
  v_fmac_f32 v13, v133, v162
  v_fmac_f32 v14, v134, v162
  v_fmac_f32 v15, v135, v162
  v_cvt_pk_bf16_f32 v16, v8, v9
  v_cvt_pk_bf16_f32 v17, v10, v11
  v_cvt_pk_bf16_f32 v18, v12, v13
  v_cvt_pk_bf16_f32 v19, v14, v15
  s_nop 2
  v_permlane16_swap_b32 v16, v18
  v_permlane16_swap_b32 v17, v19
  s_add_u32 s3, s55, 2048
  s_nop 0
  v_pk_max_i16 v16, v16, 0
  v_pk_max_i16 v18, v18, 0
  v_pk_max_i16 v17, v17, 0
  v_pk_max_i16 v19, v19, 0
  buffer_store_dwordx4 v[16:19], v166, s[40:43], s3 offen sc1
  s_mov_b32 s96, s19
  s_mov_b32 s97, 1
  s_branch L_ATT
.p2align 7
L_ATT:
  v_mov_b32 v136, 0xf149f2ca
  s_and_b32 s3, s96, 3
  s_lshl_b32 s26, s20, 2
  s_add_u32 s26, s26, s3
  s_add_u32 s25, s26, 1
  s_min_u32 s25, s25, 9
  s_lshr_b32 s62, s96, 2
  s_lshl_b32 s27, s23, 1
  s_add_u32 s27, s27, s62
  v_lshlrev_b32 v1, 4, v0
  s_lshl_b32 s63, s96, 10
  s_add_u32 s63, s63, 147456
  v_add_u32 v3, s63, v1
  s_mul_i32 s62, s62, 12288
  s_lshl_b32 s3, s3, 10
  s_add_u32 s3, s3, s62
  s_add_u32 s62, s3, 65536
  v_add_u32 v4, s62, v1
  v_lshrrev_b32 v5, 5, v0
  v_lshlrev_b32 v5, 2, v5
  v_bfe_u32 v6, v0, 2, 2
  v_add_u32 v5, v5, v6
  v_lshlrev_b32 v5, 4, v5
  v_bfe_u32 v6, v0, 1, 1
  v_lshl_add_u32 v5, v6, 9, v5
  v_and_b32 v6, 1, v0
  v_lshl_add_u32 v5, v6, 3, v5
  s_add_u32 s3, s3, 98304
  v_add_u32 v5, s3, v5
  v_mov_b32 v6, 155648
  v_mov_b32 v7, 1024
  s_mov_b32 s98, 0xffff
  s_mov_b32 s99, 0xffff
  v_cndmask_b32 v5, v6, v5, s[98:99]
  v_cndmask_b32 v149, 0, v7, s[98:99]
  v_lshlrev_b32 v7, 3, v149
  v_sub_u32 v150, v5, v7
  v_mov_b32 v2, 161792
  s_mov_b32 s63, 0x400000
LW_53:
  ds_read_b32 v6, v2 offset:16
  s_sub_u32 s63, s63, 1
  s_waitcnt lgkmcnt(0)
  v_readfirstlane_b32 s62, v6
  s_cmp_eq_u32 s63, 0
  s_cbranch_scc1 LWOK_54
  s_cmp_ge_u32 s62, 8
  s_cbranch_scc1 LWOK_54
  s_sleep 1
  s_branch LW_53
LWOK_54:
  s_setprio 3
  v_add_u32 v2, 155648, v1
  ds_read_b128 v[8:11], v3
  ds_read_b128 v[12:15], v4 offset:8192
  ds_read_b128 v[44:47], v4 offset:0
  ds_read_b128 v[16:19], v4 offset:7168
  v_mov_b32 v148, v5
  ds_read_b64_tr_b16 v[48:49], v148 offset:0
  ds_read_b64_tr_b16 v[50:51], v148 offset:128
  ds_read_b64_tr_b16 v[52:53], v148 offset:256
  ds_read_b64_tr_b16 v[54:55], v148 offset:384
  ds_read_b64_tr_b16 v[56:57], v150 offset:0
  ds_read_b64_tr_b16 v[58:59], v150 offset:128
  ds_read_b64_tr_b16 v[60:61], v150 offset:256
  ds_read_b64_tr_b16 v[62:63], v150 offset:384
  s_waitcnt lgkmcnt(10)
  v_mfma_f32_32x32x16_bf16 v[64:79], v[12:15], v[8:11], 0
  s_waitcnt lgkmcnt(9)
  v_mfma_f32_32x32x16_bf16 v[96:111], v[44:47], v[8:11], 0
  s_waitcnt lgkmcnt(8)
  v_mfma_f32_32x32x16_bf16 v[80:95], v[16:19], v[8:11], 0
  s_waitcnt lgkmcnt(4)
  ds_read_b128 v[140:143], v2 offset:1024
  ds_read_b128 v[144:147], v2 offset:2048
  ds_read_b128 v[20:23], v4 offset:6144
  ds_read_b128 v[24:27], v4 offset:5120
  ds_read_b128 v[28:31], v4 offset:4096
  ds_read_b128 v[32:35], v4 offset:3072
  ds_read_b128 v[36:39], v4 offset:2048
  ds_read_b128 v[40:43], v4 offset:1024
  s_nop 2
  v_cndmask_b32 v64, v96, v64, s[64:65]
  v_cndmask_b32 v65, v97, v65, s[66:67]
  v_cndmask_b32 v66, v98, v66, s[68:69]
  v_cndmask_b32 v67, v99, v67, s[70:71]
  v_cndmask_b32 v68, v100, v68, s[72:73]
  v_cndmask_b32 v69, v101, v69, s[74:75]
  v_cndmask_b32 v70, v102, v70, s[76:77]
  v_cndmask_b32 v71, v103, v71, s[78:79]
  v_cndmask_b32 v72, v104, v72, s[80:81]
  v_cndmask_b32 v73, v105, v73, s[82:83]
  v_cndmask_b32 v74, v106, v74, s[84:85]
  v_cndmask_b32 v75, v107, v75, s[86:87]
  v_cndmask_b32 v76, v108, v76, s[88:89]
  v_cndmask_b32 v77, v109, v77, s[90:91]
  v_cndmask_b32 v78, v110, v78, s[92:93]
  v_cndmask_b32 v79, v111, v79, s[94:95]
  v_exp_f32 v64, v64
  v_exp_f32 v65, v65
  v_exp_f32 v66, v66
  v_exp_f32 v67, v67
  v_exp_f32 v68, v68
  v_exp_f32 v69, v69
  v_exp_f32 v70, v70
  v_exp_f32 v71, v71
  v_exp_f32 v72, v72
  v_exp_f32 v73, v73
  v_exp_f32 v74, v74
  v_exp_f32 v75, v75
  v_exp_f32 v76, v76
  v_exp_f32 v77, v77
  v_exp_f32 v78, v78
  v_exp_f32 v79, v79
  v_cvt_pk_bf16_f32 v112, v64, v65
  v_cvt_pk_bf16_f32 v113, v66, v67
  v_cvt_pk_bf16_f32 v114, v68, v69
  v_cvt_pk_bf16_f32 v115, v70, v71
  v_cvt_pk_bf16_f32 v116, v72, v73
  v_cvt_pk_bf16_f32 v117, v74, v75
  v_cvt_pk_bf16_f32 v118, v76, v77
  v_cvt_pk_bf16_f32 v119, v78, v79
  s_waitcnt lgkmcnt(6)
  v_and_b32 v96, v140, v112
  v_and_b32 v97, v141, v113
  v_and_b32 v98, v142, v114
  v_and_b32 v99, v143, v115
  v_and_b32 v100, v144, v116
  v_and_b32 v101, v145, v117
  v_and_b32 v102, v146, v118
  v_and_b32 v103, v147, v119
  v_mfma_f32_32x32x16_bf16 v[120:135], v[48:51], v[96:99], 0
  v_bfi_b32 v104, v140, 0, v112
  v_bfi_b32 v105, v141, 0, v113
  v_bfi_b32 v106, v142, 0, v114
  v_bfi_b32 v107, v143, 0, v115
  v_bfi_b32 v108, v144, 0, v116
  v_bfi_b32 v109, v145, 0, v117
  v_bfi_b32 v110, v146, 0, v118
  v_bfi_b32 v111, v147, 0, v119
  v_mfma_f32_32x32x16_bf16 v[120:135], v[52:55], v[100:103], v[120:135]
  s_cmp_lt_u32 s25, 9
  s_cbranch_scc1 L_NOFAR
  v_mfma_f32_32x32x16_bf16 v[120:135], v[56:59], v[104:107], v[120:135]
  v_mfma_f32_32x32x16_bf16 v[120:135], v[60:63], v[108:111], v[120:135]
L_NOFAR:
  v_sub_u32 v148, v148, v149
  ds_read_b64_tr_b16 v[56:57], v148 offset:0
  ds_read_b64_tr_b16 v[58:59], v148 offset:128
  ds_read_b64_tr_b16 v[60:61], v148 offset:256
  ds_read_b64_tr_b16 v[62:63], v148 offset:384
  s_cmp_eq_u32 s25, 1
  s_cbranch_scc1 L_FCHK
  s_waitcnt lgkmcnt(9)
  v_mfma_f32_32x32x16_bf16 v[64:79], v[20:23], v[8:11], 0
  v_exp_f32 v80, v80
  v_exp_f32 v81, v81
  v_sub_u32 v148, v148, v149
  ds_read_b64_tr_b16 v[48:49], v148 offset:0
  ds_read_b64_tr_b16 v[50:51], v148 offset:128
  ds_read_b64_tr_b16 v[52:53], v148 offset:256
  ds_read_b64_tr_b16 v[54:55], v148 offset:384
  v_exp_f32 v82, v82
  v_exp_f32 v83, v83
  v_exp_f32 v84, v84
  v_exp_f32 v85, v85
  v_exp_f32 v86, v86
  v_exp_f32 v87, v87
  v_cvt_pk_bf16_f32 v112, v80, v81
  v_cvt_pk_bf16_f32 v113, v82, v83
  v_cvt_pk_bf16_f32 v114, v84, v85
  v_cvt_pk_bf16_f32 v115, v86, v87
  v_exp_f32 v88, v88
  v_exp_f32 v89, v89
  s_waitcnt lgkmcnt(4)
  v_mfma_f32_32x32x16_bf16 v[120:135], v[56:59], v[112:115], v[120:135]
  v_exp_f32 v90, v90
  v_exp_f32 v91, v91
  v_exp_f32 v92, v92
  v_exp_f32 v93, v93
  v_exp_f32 v94, v94
  v_exp_f32 v95, v95
  v_cvt_pk_bf16_f32 v116, v88, v89
  v_cvt_pk_bf16_f32 v117, v90, v91
  v_cvt_pk_bf16_f32 v118, v92, v93
  v_cvt_pk_bf16_f32 v119, v94, v95
  s_cmp_eq_u32 s25, 2
  s_cbranch_scc1 L_FX1
  v_mfma_f32_32x32x16_bf16 v[80:95], v[24:27], v[8:11], 0
  v_exp_f32 v64, v64
  v_exp_f32 v65, v65
  v_mfma_f32_32x32x16_bf16 v[120:135], v[60:63], v[116:119], v[120:135]
  v_sub_u32 v148, v148, v149
  ds_read_b64_tr_b16 v[56:57], v148 offset:0
  ds_read_b64_tr_b16 v[58:59], v148 offset:128
  ds_read_b64_tr_b16 v[60:61], v148 offset:256
  ds_read_b64_tr_b16 v[62:63], v148 offset:384
  v_exp_f32 v66, v66
  v_exp_f32 v67, v67
  v_exp_f32 v68, v68
  v_exp_f32 v69, v69
  v_exp_f32 v70, v70
  v_exp_f32 v71, v71
  v_cvt_pk_bf16_f32 v112, v64, v65
  v_cvt_pk_bf16_f32 v113, v66, v67
  v_cvt_pk_bf16_f32 v114, v68, v69
  v_cvt_pk_bf16_f32 v115, v70, v71
  v_exp_f32 v72, v72
  v_exp_f32 v73, v73
  s_waitcnt lgkmcnt(4)
  v_mfma_f32_32x32x16_bf16 v[120:135], v[48:51], v[112:115], v[120:135]
  v_exp_f32 v74, v74
  v_exp_f32 v75, v75
  v_exp_f32 v76, v76
  v_exp_f32 v77, v77
  v_exp_f32 v78, v78
  v_exp_f32 v79, v79
  v_cvt_pk_bf16_f32 v116, v72, v73
  v_cvt_pk_bf16_f32 v117, v74, v75
  v_cvt_pk_bf16_f32 v118, v76, v77
  v_cvt_pk_bf16_f32 v119, v78, v79
  s_cmp_eq_u32 s97, 0
  s_cbranch_scc1 NOOWE_55
  s_waitcnt vmcnt(0)
  v_mov_b32 v152, 161792
  v_mov_b32 v153, 1
  s_mov_b64 exec, 1
  ds_add_rtn_u32 v153, v152, v153 offset:12
  s_add_u32 s62, s24, 0xfa0000
  s_waitcnt lgkmcnt(0)
  v_readfirstlane_b32 s63, v153
  s_cmp_lg_u32 s63, 3
  s_cbranch_scc1 NOFLAG_56
  v_mov_b32 v152, 0
  v_mov_b32 v153, s61
  buffer_store_dword v153, v152, s[40:43], s62 offen sc1
NOFLAG_56:
  s_mov_b64 exec, -1
  s_mov_b32 s97, 0
NOOWE_55:
  s_cmp_eq_u32 s25, 3
  s_cbranch_scc1 L_FX0
  v_mfma_f32_32x32x16_bf16 v[64:79], v[28:31], v[8:11], 0
  v_exp_f32 v80, v80
  v_exp_f32 v81, v81
  v_mfma_f32_32x32x16_bf16 v[120:135], v[52:55], v[116:119], v[120:135]
  v_sub_u32 v148, v148, v149
  ds_read_b64_tr_b16 v[48:49], v148 offset:0
  ds_read_b64_tr_b16 v[50:51], v148 offset:128
  ds_read_b64_tr_b16 v[52:53], v148 offset:256
  ds_read_b64_tr_b16 v[54:55], v148 offset:384
  v_exp_f32 v82, v82
  v_exp_f32 v83, v83
  v_exp_f32 v84, v84
  v_exp_f32 v85, v85
  v_exp_f32 v86, v86
  v_exp_f32 v87, v87
  v_cvt_pk_bf16_f32 v112, v80, v81
  v_cvt_pk_bf16_f32 v113, v82, v83
  v_cvt_pk_bf16_f32 v114, v84, v85
  v_cvt_pk_bf16_f32 v115, v86, v87
  v_exp_f32 v88, v88
  v_exp_f32 v89, v89
  s_waitcnt lgkmcnt(4)
  v_mfma_f32_32x32x16_bf16 v[120:135], v[56:59], v[112:115], v[120:135]
  v_exp_f32 v90, v90
  v_exp_f32 v91, v91
  v_exp_f32 v92, v92
  v_exp_f32 v93, v93
  v_exp_f32 v94, v94
  v_exp_f32 v95, v95
  v_cvt_pk_bf16_f32 v116, v88, v89
  v_cvt_pk_bf16_f32 v117, v90, v91
  v_cvt_pk_bf16_f32 v118, v92, v93
  v_cvt_pk_bf16_f32 v119, v94, v95
  s_cmp_eq_u32 s25, 4
  s_cbranch_scc1 L_FX1
  v_mfma_f32_32x32x16_bf16 v[80:95], v[32:35], v[8:11], 0
  v_exp_f32 v64, v64
  v_exp_f32 v65, v65
  v_mfma_f32_32x32x16_bf16 v[120:135], v[60:63], v[116:119], v[120:135]
  v_sub_u32 v148, v148, v149
  ds_read_b64_tr_b16 v[56:57], v148 offset:0
  ds_read_b64_tr_b16 v[58:59], v148 offset:128
  ds_read_b64_tr_b16 v[60:61], v148 offset:256
  ds_read_b64_tr_b16 v[62:63], v148 offset:384
  v_exp_f32 v66, v66
  v_exp_f32 v67, v67
  v_exp_f32 v68, v68
  v_exp_f32 v69, v69
  v_exp_f32 v70, v70
  v_exp_f32 v71, v71
  v_cvt_pk_bf16_f32 v112, v64, v65
  v_cvt_pk_bf16_f32 v113, v66, v67
  v_cvt_pk_bf16_f32 v114, v68, v69
  v_cvt_pk_bf16_f32 v115, v70, v71
  v_exp_f32 v72, v72
  v_exp_f32 v73, v73
  s_waitcnt lgkmcnt(4)
  v_mfma_f32_32x32x16_bf16 v[120:135], v[48:51], v[112:115], v[120:135]
  v_exp_f32 v74, v74
  v_exp_f32 v75, v75
  v_exp_f32 v76, v76
  v_exp_f32 v77, v77
  v_exp_f32 v78, v78
  v_exp_f32 v79, v79
  v_cvt_pk_bf16_f32 v116, v72, v73
  v_cvt_pk_bf16_f32 v117, v74, v75
  v_cvt_pk_bf16_f32 v118, v76, v77
  v_cvt_pk_bf16_f32 v119, v78, v79
  s_cmp_eq_u32 s25, 5
  s_cbranch_scc1 L_FX0
  v_mfma_f32_32x32x16_bf16 v[64:79], v[36:39], v[8:11], 0
  v_exp_f32 v80, v80
  v_exp_f32 v81, v81
  v_mfma_f32_32x32x16_bf16 v[120:135], v[52:55], v[116:119], v[120:135]
  v_sub_u32 v148, v148, v149
  ds_read_b64_tr_b16 v[48:49], v148 offset:0
  ds_read_b64_tr_b16 v[50:51], v148 offset:128
  ds_read_b64_tr_b16 v[52:53], v148 offset:256
  ds_read_b64_tr_b16 v[54:55], v148 offset:384
  v_exp_f32 v82, v82
  v_exp_f32 v83, v83
  v_exp_f32 v84, v84
  v_exp_f32 v85, v85
  v_exp_f32 v86, v86
  v_exp_f32 v87, v87
  v_cvt_pk_bf16_f32 v112, v80, v81
  v_cvt_pk_bf16_f32 v113, v82, v83
  v_cvt_pk_bf16_f32 v114, v84, v85
  v_cvt_pk_bf16_f32 v115, v86, v87
  v_exp_f32 v88, v88
  v_exp_f32 v89, v89
  s_waitcnt lgkmcnt(4)
  v_mfma_f32_32x32x16_bf16 v[120:135], v[56:59], v[112:115], v[120:135]
  v_exp_f32 v90, v90
  v_exp_f32 v91, v91
  v_exp_f32 v92, v92
  v_exp_f32 v93, v93
  v_exp_f32 v94, v94
  v_exp_f32 v95, v95
  v_cvt_pk_bf16_f32 v116, v88, v89
  v_cvt_pk_bf16_f32 v117, v90, v91
  v_cvt_pk_bf16_f32 v118, v92, v93
  v_cvt_pk_bf16_f32 v119, v94, v95
  s_cmp_eq_u32 s25, 6
  s_cbranch_scc1 L_FX1
  v_mfma_f32_32x32x16_bf16 v[80:95], v[40:43], v[8:11], 0
  v_exp_f32 v64, v64
  v_exp_f32 v65, v65
  v_mfma_f32_32x32x16_bf16 v[120:135], v[60:63], v[116:119], v[120:135]
  v_sub_u32 v148, v148, v149
  ds_read_b64_tr_b16 v[56:57], v148 offset:0
  ds_read_b64_tr_b16 v[58:59], v148 offset:128
  ds_read_b64_tr_b16 v[60:61], v148 offset:256
  ds_read_b64_tr_b16 v[62:63], v148 offset:384
  v_exp_f32 v66, v66
  v_exp_f32 v67, v67
  v_exp_f32 v68, v68
  v_exp_f32 v69, v69
  v_exp_f32 v70, v70
  v_exp_f32 v71, v71
  v_cvt_pk_bf16_f32 v112, v64, v65
  v_cvt_pk_bf16_f32 v113, v66, v67
  v_cvt_pk_bf16_f32 v114, v68, v69
  v_cvt_pk_bf16_f32 v115, v70, v71
  v_exp_f32 v72, v72
  v_exp_f32 v73, v73
  s_waitcnt lgkmcnt(4)
  v_mfma_f32_32x32x16_bf16 v[120:135], v[48:51], v[112:115], v[120:135]
  v_exp_f32 v74, v74
  v_exp_f32 v75, v75
  v_exp_f32 v76, v76
  v_exp_f32 v77, v77
  v_exp_f32 v78, v78
  v_exp_f32 v79, v79
  v_cvt_pk_bf16_f32 v116, v72, v73
  v_cvt_pk_bf16_f32 v117, v74, v75
  v_cvt_pk_bf16_f32 v118, v76, v77
  v_cvt_pk_bf16_f32 v119, v78, v79
  s_cmp_eq_u32 s25, 7
  s_cbranch_scc1 L_FX0
  v_exp_f32 v80, v80
  v_exp_f32 v81, v81
  v_mfma_f32_32x32x16_bf16 v[120:135], v[52:55], v[116:119], v[120:135]
  v_exp_f32 v82, v82
  v_exp_f32 v83, v83
  v_exp_f32 v84, v84
  v_exp_f32 v85, v85
  v_exp_f32 v86, v86
  v_exp_f32 v87, v87
  v_cvt_pk_bf16_f32 v112, v80, v81
  v_cvt_pk_bf16_f32 v113, v82, v83
  v_cvt_pk_bf16_f32 v114, v84, v85
  v_cvt_pk_bf16_f32 v115, v86, v87
  v_exp_f32 v88, v88
  v_exp_f32 v89, v89
  s_waitcnt lgkmcnt(0)
  v_mfma_f32_32x32x16_bf16 v[120:135], v[56:59], v[112:115], v[120:135]
  v_exp_f32 v90, v90
  v_exp_f32 v91, v91
  v_exp_f32 v92, v92
  v_exp_f32 v93, v93
  v_exp_f32 v94, v94
  v_exp_f32 v95, v95
  v_cvt_pk_bf16_f32 v116, v88, v89
  v_cvt_pk_bf16_f32 v117, v90, v91
  v_cvt_pk_bf16_f32 v118, v92, v93
  v_cvt_pk_bf16_f32 v119, v94, v95
L_FX1:
  s_nop 1
  v_mfma_f32_32x32x16_bf16 v[120:135], v[60:63], v[116:119], v[120:135]
  s_branch L_FCHK
L_FX0:
  s_nop 1
  v_mfma_f32_32x32x16_bf16 v[120:135], v[52:55], v[116:119], v[120:135]
L_FCHK:
  s_cmp_eq_u32 s97, 0
  s_cbranch_scc1 NOOWE_57
  s_waitcnt vmcnt(0)
  v_mov_b32 v152, 161792
  v_mov_b32 v153, 1
  s_mov_b64 exec, 1
  ds_add_rtn_u32 v153, v152, v153 offset:12
  s_add_u32 s62, s24, 0xfa0000
  s_waitcnt lgkmcnt(0)
  v_readfirstlane_b32 s63, v153
  s_cmp_lg_u32 s63, 3
  s_cbranch_scc1 NOFLAG_58
  v_mov_b32 v152, 0
  v_mov_b32 v153, s61
  buffer_store_dword v153, v152, s[40:43], s62 offen sc1
NOFLAG_58:
  s_mov_b64 exec, -1
  s_mov_b32 s97, 0
NOOWE_57:
  s_mov_b32 s52, 0x1f800000
  s_mov_b32 s53, 0x5f800000
  s_mov_b32 s3, 0x7f800000
  s_waitcnt lgkmcnt(0)
  s_nop 7
  v_add_f32 v6, |v120|, |v121|
  v_add_f32 v7, |v122|, |v123|
  v_add_f32 v2, |v124|, |v125|
  v_add_f32 v3, |v126|, |v127|
  v_cmp_le_f32 s[62:63], s52, v128
  v_cmp_ge_f32 s[98:99], s53, v128
  v_add_f32 v6, v6, v7
  v_add_f32 v2, v2, v3
  v_add_f32 v6, v6, v2
  s_and_b64 s[62:63], s[62:63], s[98:99]
  v_cmp_gt_f32 vcc, s3, v6
  s_nop 0
  s_and_b64 s[62:63], s[62:63], vcc
  s_cmp_eq_u64 s[62:63], -1
  s_cbranch_scc0 L_SLOW
L_P2DONE:
  s_lshl_b32 s3, s26, 5
  s_add_u32 s3, s3, s27
  s_lshl_b32 s3, s3, 10
  s_add_u32 s3, s3, 0xd00000
  v_rcp_f32 v7, v128
  s_nop 0
  v_mul_f32 v120, v120, v7
  v_mul_f32 v121, v121, v7
  v_mul_f32 v122, v122, v7
  v_mul_f32 v123, v123, v7
  v_mul_f32 v124, v124, v7
  v_mul_f32 v125, v125, v7
  v_mul_f32 v126, v126, v7
  v_mul_f32 v127, v127, v7
  v_cvt_pk_bf16_f32 v112, v120, v121
  v_cvt_pk_bf16_f32 v113, v122, v123
  v_cvt_pk_bf16_f32 v114, v124, v125
  v_cvt_pk_bf16_f32 v115, v126, v127
  buffer_store_dwordx4 v[112:115], v1, s[40:43], s3 offen sc1
  s_waitcnt vmcnt(0)
  v_mov_b32 v2, 161792
  v_mov_b32 v3, 1
  s_mov_b64 exec, 1
  ds_add_rtn_u32 v3, v2, v3 offset:8
  s_add_u32 s62, s24, 0xfb0000
  s_waitcnt lgkmcnt(0)
  v_readfirstlane_b32 s63, v3
  s_cmp_lg_u32 s63, 7
  s_cbranch_scc1 NOFLAG_59
  v_mov_b32 v2, 0
  v_mov_b32 v3, s61
  buffer_store_dword v3, v2, s[40:43], s62 offen sc1
NOFLAG_59:
  s_mov_b64 exec, -1
  s_cmp_lg_u32 s2, 0
  s_cbranch_scc1 L_FIN
  s_cmp_lg_u32 s96, 1
  s_cbranch_scc1 L_FIN
  v_lshlrev_b32 v6, 7, v0
  s_mov_b32 s63, 0x20000
L_BCHK:
  s_mov_b32 s62, 0xfb0000
  buffer_load_dword v8, v6, s[40:43], s62 offen sc1
  s_mov_b32 s62, 0xfb2000
  buffer_load_dword v9, v6, s[40:43], s62 offen sc1
  s_mov_b32 s62, 0xfb4000
  buffer_load_dword v10, v6, s[40:43], s62 offen sc1
  s_mov_b32 s62, 0xfb6000
  buffer_load_dword v11, v6, s[40:43], s62 offen sc1
  s_waitcnt vmcnt(0)
  v_xor_b32 v7, s61, v8
  v_bitop3_b32 v7, v7, v9, s61 bitop3:0xf6
  v_bitop3_b32 v7, v7, v10, s61 bitop3:0xf6
  v_bitop3_b32 v7, v7, v11, s61 bitop3:0xf6
  v_cmp_ne_u32 vcc, 0, v7
  s_sub_u32 s63, s63, 1
  s_cmp_eq_u32 s63, 0
  s_cbranch_scc1 L_FIN
  s_cmp_lg_u64 vcc, 0
  s_cbranch_scc1 L_BCHK
  s_mov_b64 exec, 1
  v_mov_b32 v6, 0
  v_mov_b32 v7, s61
  s_mov_b32 s62, 0xf80000
  buffer_store_dword v7, v6, s[40:43], s62 offen sc1
  s_mov_b64 exec, -1
L_FIN:
  s_mov_b32 s28, s10
  s_and_b32 s29, s11, 0xffff
  s_mov_b32 s30, 0x200000
  s_mov_b32 s31, 0x20000
  v_lshrrev_b32 v7, 3, v0
  v_and_b32 v14, 7, v0
  v_lshlrev_b32 v8, 4, v14
  v_lshl_add_u32 v2, v7, 10, v8
  s_lshl_b32 s62, s58, 16
  s_lshl_b32 s3, s96, 13
  s_add_u32 s62, s62, s3
  s_lshl_b32 s3, s59, 7
  s_add_u32 s62, s62, s3
  buffer_load_dwordx4 v[8:11], v2, s[36:39], s62 offen
  s_and_b32 s3, s96, 3
  s_lshl_b32 s3, s3, 10
  s_cmp_ge_u32 s96, 4
  s_mov_b32 s63, 0
  s_cselect_b32 s63, 32768, s63
  s_mov_b32 s64, 16384
  s_cselect_b32 s64, 49152, s64
  s_add_u32 s63, s63, s3
  s_add_u32 s64, s64, s3
  v_and_b32 v12, 3, v0
  v_lshlrev_b32 v12, 1, v12
  v_xor_b32 v12, v12, v7
  v_bfe_u32 v13, v0, 2, 1
  v_xor_b32 v12, v12, v13
  v_lshlrev_b32 v12, 4, v12
  v_lshl_add_u32 v12, v7, 7, v12
  v_mov_b32 v15, s63
  v_mov_b32 v16, s64
  v_cmp_eq_u32 vcc, 1, v13
  s_nop 1
  v_cndmask_b32 v15, v15, v16, vcc
  v_add_u32 v24, v15, v12
  v_xor_b32 v25, 16, v24
  s_barrier
  ds_read_b128 v[48:51], v24 offset:0
  ds_read_b128 v[52:55], v25 offset:0
  ds_read_b128 v[56:59], v24 offset:4096
  ds_read_b128 v[60:63], v25 offset:4096
  ds_read_b128 v[64:67], v24 offset:8192
  ds_read_b128 v[68:71], v25 offset:8192
  ds_read_b128 v[72:75], v24 offset:12288
  ds_read_b128 v[76:79], v25 offset:12288
  s_mov_b32 s3, 0xffff0000
  s_waitcnt vmcnt(0)
  v_lshlrev_b32 v32, 16, v8
  v_and_b32 v33, s3, v8
  v_lshlrev_b32 v34, 16, v9
  v_and_b32 v35, s3, v9
  v_lshlrev_b32 v36, 16, v10
  v_and_b32 v37, s3, v10
  v_lshlrev_b32 v38, 16, v11
  v_and_b32 v39, s3, v11
  s_waitcnt lgkmcnt(6)
  v_add_f32 v32, v32, v48
  v_add_f32 v33, v33, v49
  v_add_f32 v34, v34, v50
  v_add_f32 v35, v35, v51
  v_add_f32 v36, v36, v52
  v_add_f32 v37, v37, v53
  v_add_f32 v38, v38, v54
  v_add_f32 v39, v39, v55
  s_waitcnt lgkmcnt(4)
  v_add_f32 v32, v32, v56
  v_add_f32 v33, v33, v57
  v_add_f32 v34, v34, v58
  v_add_f32 v35, v35, v59
  v_add_f32 v36, v36, v60
  v_add_f32 v37, v37, v61
  v_add_f32 v38, v38, v62
  v_add_f32 v39, v39, v63
  s_waitcnt lgkmcnt(2)
  v_add_f32 v32, v32, v64
  v_add_f32 v33, v33, v65
  v_add_f32 v34, v34, v66
  v_add_f32 v35, v35, v67
  v_add_f32 v36, v36, v68
  v_add_f32 v37, v37, v69
  v_add_f32 v38, v38, v70
  v_add_f32 v39, v39, v71
  s_waitcnt lgkmcnt(0)
  v_add_f32 v32, v32, v72
  v_add_f32 v33, v33, v73
  v_add_f32 v34, v34, v74
  v_add_f32 v35, v35, v75
  v_add_f32 v36, v36, v76
  v_add_f32 v37, v37, v77
  v_add_f32 v38, v38, v78
  v_add_f32 v39, v39, v79
  v_cvt_pk_bf16_f32 v40, v32, v33
  v_cvt_pk_bf16_f32 v41, v34, v35
  v_cvt_pk_bf16_f32 v42, v36, v37
  v_cvt_pk_bf16_f32 v43, v38, v39
  buffer_store_dwordx4 v[40:43], v2, s[28:31], s62 offen nt
L_END0:
  s_endpgm
L_SLOW:
  v_mov_b32 v137, v136
  v_mov_b32 v138, v136
  v_cndmask_b32 v64, v136, 0, s[64:65]
  v_cndmask_b32 v65, v136, 0, s[66:67]
  v_cndmask_b32 v66, v136, 0, s[68:69]
  v_cndmask_b32 v67, v136, 0, s[70:71]
  v_cndmask_b32 v68, v136, 0, s[72:73]
  v_cndmask_b32 v69, v136, 0, s[74:75]
  v_cndmask_b32 v70, v136, 0, s[76:77]
  v_cndmask_b32 v71, v136, 0, s[78:79]
  v_cndmask_b32 v72, v136, 0, s[80:81]
  v_cndmask_b32 v73, v136, 0, s[82:83]
  v_cndmask_b32 v74, v136, 0, s[84:85]
  v_cndmask_b32 v75, v136, 0, s[86:87]
  v_cndmask_b32 v76, v136, 0, s[88:89]
  v_cndmask_b32 v77, v136, 0, s[90:91]
  v_cndmask_b32 v78, v136, 0, s[92:93]
  v_cndmask_b32 v79, v136, 0, s[94:95]
  s_nop 1
  v_mfma_f32_32x32x16_bf16 v[64:79], v[12:15], v[8:11], v[64:79]
  v_mfma_f32_32x32x16_bf16 v[80:95], v[16:19], v[8:11], 0
  v_mfma_f32_32x32x16_bf16 v[96:111], v[20:23], v[8:11], 0
  s_nop 9
  v_max3_f32 v137, v64, v65, v137
  v_max3_f32 v138, v66, v67, v138
  v_max3_f32 v137, v68, v69, v137
  v_max3_f32 v138, v70, v71, v138
  v_max3_f32 v137, v72, v73, v137
  v_max3_f32 v138, v74, v75, v138
  v_max3_f32 v137, v76, v77, v137
  v_max3_f32 v138, v78, v79, v138
  s_cmp_eq_u32 s25, 1
  s_cbranch_scc1 L_P1DONE
  v_mfma_f32_32x32x16_bf16 v[64:79], v[24:27], v[8:11], 0
  v_max3_f32 v137, v80, v81, v137
  v_max3_f32 v138, v82, v83, v138
  v_max3_f32 v137, v84, v85, v137
  v_max3_f32 v138, v86, v87, v138
  v_max3_f32 v137, v88, v89, v137
  v_max3_f32 v138, v90, v91, v138
  v_max3_f32 v137, v92, v93, v137
  v_max3_f32 v138, v94, v95, v138
  s_cmp_eq_u32 s25, 2
  s_cbranch_scc1 L_P1DONE
  v_mfma_f32_32x32x16_bf16 v[80:95], v[28:31], v[8:11], 0
  v_max3_f32 v137, v96, v97, v137
  v_max3_f32 v138, v98, v99, v138
  v_max3_f32 v137, v100, v101, v137
  v_max3_f32 v138, v102, v103, v138
  v_max3_f32 v137, v104, v105, v137
  v_max3_f32 v138, v106, v107, v138
  v_max3_f32 v137, v108, v109, v137
  v_max3_f32 v138, v110, v111, v138
  s_cmp_eq_u32 s25, 3
  s_cbranch_scc1 L_P1DONE
  v_mfma_f32_32x32x16_bf16 v[96:111], v[32:35], v[8:11], 0
  v_max3_f32 v137, v64, v65, v137
  v_max3_f32 v138, v66, v67, v138
  v_max3_f32 v137, v68, v69, v137
  v_max3_f32 v138, v70, v71, v138
  v_max3_f32 v137, v72, v73, v137
  v_max3_f32 v138, v74, v75, v138
  v_max3_f32 v137, v76, v77, v137
  v_max3_f32 v138, v78, v79, v138
  s_cmp_eq_u32 s25, 4
  s_cbranch_scc1 L_P1DONE
  v_mfma_f32_32x32x16_bf16 v[64:79], v[36:39], v[8:11], 0
  v_max3_f32 v137, v80, v81, v137
  v_max3_f32 v138, v82, v83, v138
  v_max3_f32 v137, v84, v85, v137
  v_max3_f32 v138, v86, v87, v138
  v_max3_f32 v137, v88, v89, v137
  v_max3_f32 v138, v90, v91, v138
  v_max3_f32 v137, v92, v93, v137
  v_max3_f32 v138, v94, v95, v138
  s_cmp_eq_u32 s25, 5
  s_cbranch_scc1 L_P1DONE
  v_mfma_f32_32x32x16_bf16 v[80:95], v[40:43], v[8:11], 0
  v_max3_f32 v137, v96, v97, v137
  v_max3_f32 v138, v98, v99, v138
  v_max3_f32 v137, v100, v101, v137
  v_max3_f32 v138, v102, v103, v138
  v_max3_f32 v137, v104, v105, v137
  v_max3_f32 v138, v106, v107, v138
  v_max3_f32 v137, v108, v109, v137
  v_max3_f32 v138, v110, v111, v138
  s_cmp_eq_u32 s25, 6
  s_cbranch_scc1 L_P1DONE
  v_cndmask_b32 v96, 0, v136, s[64:65]
  v_cndmask_b32 v97, 0, v136, s[66:67]
  v_cndmask_b32 v98, 0, v136, s[68:69]
  v_cndmask_b32 v99, 0, v136, s[70:71]
  v_cndmask_b32 v100, 0, v136, s[72:73]
  v_cndmask_b32 v101, 0, v136, s[74:75]
  v_cndmask_b32 v102, 0, v136, s[76:77]
  v_cndmask_b32 v103, 0, v136, s[78:79]
  v_cndmask_b32 v104, 0, v136, s[80:81]
  v_cndmask_b32 v105, 0, v136, s[82:83]
  v_cndmask_b32 v106, 0, v136, s[84:85]
  v_cndmask_b32 v107, 0, v136, s[86:87]
  v_cndmask_b32 v108, 0, v136, s[88:89]
  v_cndmask_b32 v109, 0, v136, s[90:91]
  v_cndmask_b32 v110, 0, v136, s[92:93]
  v_cndmask_b32 v111, 0, v136, s[94:95]
  s_nop 1
  v_mfma_f32_32x32x16_bf16 v[96:111], v[44:47], v[8:11], v[96:111]
  v_max3_f32 v137, v64, v65, v137
  v_max3_f32 v138, v66, v67, v138
  v_max3_f32 v137, v68, v69, v137
  v_max3_f32 v138, v70, v71, v138
  v_max3_f32 v137, v72, v73, v137
  v_max3_f32 v138, v74, v75, v138
  v_max3_f32 v137, v76, v77, v137
  v_max3_f32 v138, v78, v79, v138
  s_cmp_eq_u32 s25, 7
  s_cbranch_scc1 L_P1DONE
  v_max3_f32 v137, v80, v81, v137
  v_max3_f32 v138, v82, v83, v138
  v_max3_f32 v137, v84, v85, v137
  v_max3_f32 v138, v86, v87, v138
  v_max3_f32 v137, v88, v89, v137
  v_max3_f32 v138, v90, v91, v138
  v_max3_f32 v137, v92, v93, v137
  v_max3_f32 v138, v94, v95, v138
  s_cmp_eq_u32 s25, 8
  s_cbranch_scc1 L_P1DONE
  v_max3_f32 v137, v96, v97, v137
  v_max3_f32 v138, v98, v99, v138
  v_max3_f32 v137, v100, v101, v137
  v_max3_f32 v138, v102, v103, v138
  v_max3_f32 v137, v104, v105, v137
  v_max3_f32 v138, v106, v107, v138
  v_max3_f32 v137, v108, v109, v137
  v_max3_f32 v138, v110, v111, v138
L_P1DONE:
  v_mov_b32 v148, v5
  ds_read_b64_tr_b16 v[48:49], v148 offset:0
  ds_read_b64_tr_b16 v[50:51], v148 offset:128
  ds_read_b64_tr_b16 v[52:53], v148 offset:256
  ds_read_b64_tr_b16 v[54:55], v148 offset:384
  v_max_f32 v137, v137, v138
  v_mov_b32 v138, v137
  s_nop 1
  v_permlane32_swap_b32 v137, v138
  s_nop 1
  v_max_f32 v137, v137, v138
  v_sub_f32 v139, 0, v137
  s_nop 3
  v_mov_b32 v96, v139
  v_mov_b32 v97, v139
  v_mov_b32 v98, v139
  v_mov_b32 v99, v139
  v_mov_b32 v100, v139
  v_mov_b32 v101, v139
  v_mov_b32 v102, v139
  v_mov_b32 v103, v139
  v_mov_b32 v104, v139
  v_mov_b32 v105, v139
  v_mov_b32 v106, v139
  v_mov_b32 v107, v139
  v_mov_b32 v108, v139
  v_mov_b32 v109, v139
  v_mov_b32 v110, v139
  v_mov_b32 v111, v139
  v_cndmask_b32 v64, v136, v139, s[64:65]
  v_cndmask_b32 v65, v136, v139, s[66:67]
  v_cndmask_b32 v66, v136, v139, s[68:69]
  v_cndmask_b32 v67, v136, v139, s[70:71]
  v_cndmask_b32 v68, v136, v139, s[72:73]
  v_cndmask_b32 v69, v136, v139, s[74:75]
  v_cndmask_b32 v70, v136, v139, s[76:77]
  v_cndmask_b32 v71, v136, v139, s[78:79]
  v_cndmask_b32 v72, v136, v139, s[80:81]
  v_cndmask_b32 v73, v136, v139, s[82:83]
  v_cndmask_b32 v74, v136, v139, s[84:85]
  v_cndmask_b32 v75, v136, v139, s[86:87]
  v_cndmask_b32 v76, v136, v139, s[88:89]
  v_cndmask_b32 v77, v136, v139, s[90:91]
  v_cndmask_b32 v78, v136, v139, s[92:93]
  v_cndmask_b32 v79, v136, v139, s[94:95]
  s_nop 1
  v_mfma_f32_32x32x16_bf16 v[64:79], v[12:15], v[8:11], v[64:79]
  v_mfma_f32_32x32x16_bf16 v[80:95], v[16:19], v[8:11], v[96:111]
  v_sub_u32 v148, v148, v149
  ds_read_b64_tr_b16 v[56:57], v148 offset:0
  ds_read_b64_tr_b16 v[58:59], v148 offset:128
  ds_read_b64_tr_b16 v[60:61], v148 offset:256
  ds_read_b64_tr_b16 v[62:63], v148 offset:384
  s_nop 6
  v_exp_f32 v64, v64
  v_exp_f32 v65, v65
  v_exp_f32 v66, v66
  v_exp_f32 v67, v67
  v_exp_f32 v68, v68
  v_exp_f32 v69, v69
  v_exp_f32 v70, v70
  v_exp_f32 v71, v71
  v_cvt_pk_bf16_f32 v112, v64, v65
  v_cvt_pk_bf16_f32 v113, v66, v67
  v_cvt_pk_bf16_f32 v114, v68, v69
  v_cvt_pk_bf16_f32 v115, v70, v71
  v_exp_f32 v72, v72
  v_exp_f32 v73, v73
  v_exp_f32 v74, v74
  v_exp_f32 v75, v75
  v_exp_f32 v76, v76
  v_exp_f32 v77, v77
  v_exp_f32 v78, v78
  v_exp_f32 v79, v79
  s_waitcnt lgkmcnt(4)
  v_mfma_f32_32x32x16_bf16 v[120:135], v[48:51], v[112:115], 0
  v_cvt_pk_bf16_f32 v116, v72, v73
  v_cvt_pk_bf16_f32 v117, v74, v75
  v_cvt_pk_bf16_f32 v118, v76, v77
  v_cvt_pk_bf16_f32 v119, v78, v79
  s_nop 1
  v_mfma_f32_32x32x16_bf16 v[120:135], v[52:55], v[116:119], v[120:135]
  s_cmp_eq_u32 s25, 1
  s_cbranch_scc1 L_P2X
  v_mfma_f32_32x32x16_bf16 v[64:79], v[20:23], v[8:11], v[96:111]
  v_sub_u32 v148, v148, v149
  ds_read_b64_tr_b16 v[48:49], v148 offset:0
  ds_read_b64_tr_b16 v[50:51], v148 offset:128
  ds_read_b64_tr_b16 v[52:53], v148 offset:256
  ds_read_b64_tr_b16 v[54:55], v148 offset:384
  v_exp_f32 v80, v80
  v_exp_f32 v81, v81
  v_exp_f32 v82, v82
  v_exp_f32 v83, v83
  v_exp_f32 v84, v84
  v_exp_f32 v85, v85
  v_exp_f32 v86, v86
  v_exp_f32 v87, v87
  v_cvt_pk_bf16_f32 v112, v80, v81
  v_cvt_pk_bf16_f32 v113, v82, v83
  v_cvt_pk_bf16_f32 v114, v84, v85
  v_cvt_pk_bf16_f32 v115, v86, v87
  v_exp_f32 v88, v88
  v_exp_f32 v89, v89
  v_exp_f32 v90, v90
  v_exp_f32 v91, v91
  v_exp_f32 v92, v92
  v_exp_f32 v93, v93
  v_exp_f32 v94, v94
  v_exp_f32 v95, v95
  s_waitcnt lgkmcnt(4)
  v_mfma_f32_32x32x16_bf16 v[120:135], v[56:59], v[112:115], v[120:135]
  v_cvt_pk_bf16_f32 v116, v88, v89
  v_cvt_pk_bf16_f32 v117, v90, v91
  v_cvt_pk_bf16_f32 v118, v92, v93
  v_cvt_pk_bf16_f32 v119, v94, v95
  s_nop 1
  v_mfma_f32_32x32x16_bf16 v[120:135], v[60:63], v[116:119], v[120:135]
  s_cmp_eq_u32 s25, 2
  s_cbranch_scc1 L_P2X
  v_mfma_f32_32x32x16_bf16 v[80:95], v[24:27], v[8:11], v[96:111]
  v_sub_u32 v148, v148, v149
  ds_read_b64_tr_b16 v[56:57], v148 offset:0
  ds_read_b64_tr_b16 v[58:59], v148 offset:128
  ds_read_b64_tr_b16 v[60:61], v148 offset:256
  ds_read_b64_tr_b16 v[62:63], v148 offset:384
  v_exp_f32 v64, v64
  v_exp_f32 v65, v65
  v_exp_f32 v66, v66
  v_exp_f32 v67, v67
  v_exp_f32 v68, v68
  v_exp_f32 v69, v69
  v_exp_f32 v70, v70
  v_exp_f32 v71, v71
  v_cvt_pk_bf16_f32 v112, v64, v65
  v_cvt_pk_bf16_f32 v113, v66, v67
  v_cvt_pk_bf16_f32 v114, v68, v69
  v_cvt_pk_bf16_f32 v115, v70, v71
  v_exp_f32 v72, v72
  v_exp_f32 v73, v73
  v_exp_f32 v74, v74
  v_exp_f32 v75, v75
  v_exp_f32 v76, v76
  v_exp_f32 v77, v77
  v_exp_f32 v78, v78
  v_exp_f32 v79, v79
  s_waitcnt lgkmcnt(4)
  v_mfma_f32_32x32x16_bf16 v[120:135], v[48:51], v[112:115], v[120:135]
  v_cvt_pk_bf16_f32 v116, v72, v73
  v_cvt_pk_bf16_f32 v117, v74, v75
  v_cvt_pk_bf16_f32 v118, v76, v77
  v_cvt_pk_bf16_f32 v119, v78, v79
  s_nop 1
  v_mfma_f32_32x32x16_bf16 v[120:135], v[52:55], v[116:119], v[120:135]
  s_cmp_eq_u32 s25, 3
  s_cbranch_scc1 L_P2X
  v_mfma_f32_32x32x16_bf16 v[64:79], v[28:31], v[8:11], v[96:111]
  v_sub_u32 v148, v148, v149
  ds_read_b64_tr_b16 v[48:49], v148 offset:0
  ds_read_b64_tr_b16 v[50:51], v148 offset:128
  ds_read_b64_tr_b16 v[52:53], v148 offset:256
  ds_read_b64_tr_b16 v[54:55], v148 offset:384
  v_exp_f32 v80, v80
  v_exp_f32 v81, v81
  v_exp_f32 v82, v82
  v_exp_f32 v83, v83
  v_exp_f32 v84, v84
  v_exp_f32 v85, v85
  v_exp_f32 v86, v86
  v_exp_f32 v87, v87
  v_cvt_pk_bf16_f32 v112, v80, v81
  v_cvt_pk_bf16_f32 v113, v82, v83
  v_cvt_pk_bf16_f32 v114, v84, v85
  v_cvt_pk_bf16_f32 v115, v86, v87
  v_exp_f32 v88, v88
  v_exp_f32 v89, v89
  v_exp_f32 v90, v90
  v_exp_f32 v91, v91
  v_exp_f32 v92, v92
  v_exp_f32 v93, v93
  v_exp_f32 v94, v94
  v_exp_f32 v95, v95
  s_waitcnt lgkmcnt(4)
  v_mfma_f32_32x32x16_bf16 v[120:135], v[56:59], v[112:115], v[120:135]
  v_cvt_pk_bf16_f32 v116, v88, v89
  v_cvt_pk_bf16_f32 v117, v90, v91
  v_cvt_pk_bf16_f32 v118, v92, v93
  v_cvt_pk_bf16_f32 v119, v94, v95
  s_nop 1
  v_mfma_f32_32x32x16_bf16 v[120:135], v[60:63], v[116:119], v[120:135]
  s_cmp_eq_u32 s25, 4
  s_cbranch_scc1 L_P2X
  v_mfma_f32_32x32x16_bf16 v[80:95], v[32:35], v[8:11], v[96:111]
  v_sub_u32 v148, v148, v149
  ds_read_b64_tr_b16 v[56:57], v148 offset:0
  ds_read_b64_tr_b16 v[58:59], v148 offset:128
  ds_read_b64_tr_b16 v[60:61], v148 offset:256
  ds_read_b64_tr_b16 v[62:63], v148 offset:384
  v_exp_f32 v64, v64
  v_exp_f32 v65, v65
  v_exp_f32 v66, v66
  v_exp_f32 v67, v67
  v_exp_f32 v68, v68
  v_exp_f32 v69, v69
  v_exp_f32 v70, v70
  v_exp_f32 v71, v71
  v_cvt_pk_bf16_f32 v112, v64, v65
  v_cvt_pk_bf16_f32 v113, v66, v67
  v_cvt_pk_bf16_f32 v114, v68, v69
  v_cvt_pk_bf16_f32 v115, v70, v71
  v_exp_f32 v72, v72
  v_exp_f32 v73, v73
  v_exp_f32 v74, v74
  v_exp_f32 v75, v75
  v_exp_f32 v76, v76
  v_exp_f32 v77, v77
  v_exp_f32 v78, v78
  v_exp_f32 v79, v79
  s_waitcnt lgkmcnt(4)
  v_mfma_f32_32x32x16_bf16 v[120:135], v[48:51], v[112:115], v[120:135]
  v_cvt_pk_bf16_f32 v116, v72, v73
  v_cvt_pk_bf16_f32 v117, v74, v75
  v_cvt_pk_bf16_f32 v118, v76, v77
  v_cvt_pk_bf16_f32 v119, v78, v79
  s_nop 1
  v_mfma_f32_32x32x16_bf16 v[120:135], v[52:55], v[116:119], v[120:135]
  s_cmp_eq_u32 s25, 5
  s_cbranch_scc1 L_P2X
  v_mfma_f32_32x32x16_bf16 v[64:79], v[36:39], v[8:11], v[96:111]
  v_sub_u32 v148, v148, v149
  ds_read_b64_tr_b16 v[48:49], v148 offset:0
  ds_read_b64_tr_b16 v[50:51], v148 offset:128
  ds_read_b64_tr_b16 v[52:53], v148 offset:256
  ds_read_b64_tr_b16 v[54:55], v148 offset:384
  v_exp_f32 v80, v80
  v_exp_f32 v81, v81
  v_exp_f32 v82, v82
  v_exp_f32 v83, v83
  v_exp_f32 v84, v84
  v_exp_f32 v85, v85
  v_exp_f32 v86, v86
  v_exp_f32 v87, v87
  v_cvt_pk_bf16_f32 v112, v80, v81
  v_cvt_pk_bf16_f32 v113, v82, v83
  v_cvt_pk_bf16_f32 v114, v84, v85
  v_cvt_pk_bf16_f32 v115, v86, v87
  v_exp_f32 v88, v88
  v_exp_f32 v89, v89
  v_exp_f32 v90, v90
  v_exp_f32 v91, v91
  v_exp_f32 v92, v92
  v_exp_f32 v93, v93
  v_exp_f32 v94, v94
  v_exp_f32 v95, v95
  s_waitcnt lgkmcnt(4)
  v_mfma_f32_32x32x16_bf16 v[120:135], v[56:59], v[112:115], v[120:135]
  v_cvt_pk_bf16_f32 v116, v88, v89
  v_cvt_pk_bf16_f32 v117, v90, v91
  v_cvt_pk_bf16_f32 v118, v92, v93
  v_cvt_pk_bf16_f32 v119, v94, v95
  s_nop 1
  v_mfma_f32_32x32x16_bf16 v[120:135], v[60:63], v[116:119], v[120:135]
  s_cmp_eq_u32 s25, 6
  s_cbranch_scc1 L_P2X
  v_mfma_f32_32x32x16_bf16 v[80:95], v[40:43], v[8:11], v[96:111]
  v_sub_u32 v148, v148, v149
  ds_read_b64_tr_b16 v[56:57], v148 offset:0
  ds_read_b64_tr_b16 v[58:59], v148 offset:128
  ds_read_b64_tr_b16 v[60:61], v148 offset:256
  ds_read_b64_tr_b16 v[62:63], v148 offset:384
  v_exp_f32 v64, v64
  v_exp_f32 v65, v65
  v_exp_f32 v66, v66
  v_exp_f32 v67, v67
  v_exp_f32 v68, v68
  v_exp_f32 v69, v69
  v_exp_f32 v70, v70
  v_exp_f32 v71, v71
  v_cvt_pk_bf16_f32 v112, v64, v65
  v_cvt_pk_bf16_f32 v113, v66, v67
  v_cvt_pk_bf16_f32 v114, v68, v69
  v_cvt_pk_bf16_f32 v115, v70, v71
  v_exp_f32 v72, v72
  v_exp_f32 v73, v73
  v_exp_f32 v74, v74
  v_exp_f32 v75, v75
  v_exp_f32 v76, v76
  v_exp_f32 v77, v77
  v_exp_f32 v78, v78
  v_exp_f32 v79, v79
  s_waitcnt lgkmcnt(4)
  v_mfma_f32_32x32x16_bf16 v[120:135], v[48:51], v[112:115], v[120:135]
  v_cvt_pk_bf16_f32 v116, v72, v73
  v_cvt_pk_bf16_f32 v117, v74, v75
  v_cvt_pk_bf16_f32 v118, v76, v77
  v_cvt_pk_bf16_f32 v119, v78, v79
  s_nop 1
  v_mfma_f32_32x32x16_bf16 v[120:135], v[52:55], v[116:119], v[120:135]
  s_cmp_eq_u32 s25, 7
  s_cbranch_scc1 L_P2X
  v_cndmask_b32 v64, v139, v136, s[64:65]
  v_cndmask_b32 v65, v139, v136, s[66:67]
  v_cndmask_b32 v66, v139, v136, s[68:69]
  v_cndmask_b32 v67, v139, v136, s[70:71]
  v_cndmask_b32 v68, v139, v136, s[72:73]
  v_cndmask_b32 v69, v139, v136, s[74:75]
  v_cndmask_b32 v70, v139, v136, s[76:77]
  v_cndmask_b32 v71, v139, v136, s[78:79]
  v_cndmask_b32 v72, v139, v136, s[80:81]
  v_cndmask_b32 v73, v139, v136, s[82:83]
  v_cndmask_b32 v74, v139, v136, s[84:85]
  v_cndmask_b32 v75, v139, v136, s[86:87]
  v_cndmask_b32 v76, v139, v136, s[88:89]
  v_cndmask_b32 v77, v139, v136, s[90:91]
  v_cndmask_b32 v78, v139, v136, s[92:93]
  v_cndmask_b32 v79, v139, v136, s[94:95]
  s_nop 1
  v_mfma_f32_32x32x16_bf16 v[64:79], v[44:47], v[8:11], v[64:79]
  v_sub_u32 v148, v148, v149
  ds_read_b64_tr_b16 v[48:49], v148 offset:0
  ds_read_b64_tr_b16 v[50:51], v148 offset:128
  ds_read_b64_tr_b16 v[52:53], v148 offset:256
  ds_read_b64_tr_b16 v[54:55], v148 offset:384
  v_exp_f32 v80, v80
  v_exp_f32 v81, v81
  v_exp_f32 v82, v82
  v_exp_f32 v83, v83
  v_exp_f32 v84, v84
  v_exp_f32 v85, v85
  v_exp_f32 v86, v86
  v_exp_f32 v87, v87
  v_cvt_pk_bf16_f32 v112, v80, v81
  v_cvt_pk_bf16_f32 v113, v82, v83
  v_cvt_pk_bf16_f32 v114, v84, v85
  v_cvt_pk_bf16_f32 v115, v86, v87
  v_exp_f32 v88, v88
  v_exp_f32 v89, v89
  v_exp_f32 v90, v90
  v_exp_f32 v91, v91
  v_exp_f32 v92, v92
  v_exp_f32 v93, v93
  v_exp_f32 v94, v94
  v_exp_f32 v95, v95
  s_waitcnt lgkmcnt(4)
  v_mfma_f32_32x32x16_bf16 v[120:135], v[56:59], v[112:115], v[120:135]
  v_cvt_pk_bf16_f32 v116, v88, v89
  v_cvt_pk_bf16_f32 v117, v90, v91
  v_cvt_pk_bf16_f32 v118, v92, v93
  v_cvt_pk_bf16_f32 v119, v94, v95
  s_nop 1
  v_mfma_f32_32x32x16_bf16 v[120:135], v[60:63], v[116:119], v[120:135]
  s_cmp_eq_u32 s25, 8
  s_cbranch_scc1 L_P2X
  v_exp_f32 v64, v64
  v_exp_f32 v65, v65
  v_exp_f32 v66, v66
  v_exp_f32 v67, v67
  v_exp_f32 v68, v68
  v_exp_f32 v69, v69
  v_exp_f32 v70, v70
  v_exp_f32 v71, v71
  v_cvt_pk_bf16_f32 v112, v64, v65
  v_cvt_pk_bf16_f32 v113, v66, v67
  v_cvt_pk_bf16_f32 v114, v68, v69
  v_cvt_pk_bf16_f32 v115, v70, v71
  v_exp_f32 v72, v72
  v_exp_f32 v73, v73
  v_exp_f32 v74, v74
  v_exp_f32 v75, v75
  v_exp_f32 v76, v76
  v_exp_f32 v77, v77
  v_exp_f32 v78, v78
  v_exp_f32 v79, v79
  s_waitcnt lgkmcnt(0)
  v_mfma_f32_32x32x16_bf16 v[120:135], v[48:51], v[112:115], v[120:135]
  v_cvt_pk_bf16_f32 v116, v72, v73
  v_cvt_pk_bf16_f32 v117, v74, v75
  v_cvt_pk_bf16_f32 v118, v76, v77
  v_cvt_pk_bf16_f32 v119, v78, v79
  s_nop 1
  v_mfma_f32_32x32x16_bf16 v[120:135], v[52:55], v[116:119], v[120:135]
L_P2X:
  s_waitcnt lgkmcnt(0)
  s_nop 12
  s_branch L_P2DONE
L_END:
  s_endpgm
.section .rodata,"a"
.p2align 6
.amdhsa_kernel parallel_sum__sliding_block__dense_activation_relu__prompt_kernel
  .amdhsa_next_free_vgpr 168
  .amdhsa_next_free_sgpr 102
  .amdhsa_accum_offset 168
  .amdhsa_group_segment_fixed_size 0
  .amdhsa_kernarg_size 72
  .amdhsa_user_sgpr_count 2
  .amdhsa_user_sgpr_kernarg_segment_ptr 1
  .amdhsa_system_sgpr_workgroup_id_x 1
.end_amdhsa_kernel
```
